```python
import torch

def _softmax(x, axis=-1):
    return torch.softmax(x, dim=axis)
def _gelu(x):
    return torch.nn.functional.gelu(x, approximate="tanh")
def _silu(x):
    return torch.nn.functional.silu(x)
def _sigmoid(x):
    return torch.sigmoid(x)
def _layernorm(x, axis=-1, eps=1e-5):
    m = x.mean(dim=axis, keepdim=True)
    v = x.var(dim=axis, keepdim=True, unbiased=False)
    return (x - m) / torch.sqrt(v + eps)
def _scatter_add(tgt, idx, src, axis=0):
    return tgt.clone().index_add_(axis, idx, src)
def _segment_sum(src, seg, n):
    out = torch.zeros((n,) + src.shape[1:], dtype=src.dtype)
    return out.index_add_(0, seg, src)
def _pad(x, pw):
    flat = tuple(v for pair in reversed(pw) for v in pair)
    return torch.nn.functional.pad(x, flat)

kernel_name = 'sequential_preLN__mha_block_cached__glu_gated_glu__decode'

def setup_inputs():

    _w = (lambda a: (lambda t: t.to(torch.bfloat16) if t.is_floating_point() else t)(torch.as_tensor(a)))
    def _A_setup():
        B, Sq, D = 1, 1, 640
        H, Sk, Dh = 32, 32768, 192
        return {
            "x": _w((lambda *s: torch.randn(*s, dtype=torch.bfloat16) * 0.05)(B, Sq, D)),
            "k_cache": _w((lambda *s: torch.randn(*s, dtype=torch.bfloat16) * 3.2)(B, H, Sk, Dh)),
            "v_cache": _w((lambda *s: torch.randn(*s, dtype=torch.bfloat16) * 0.4)(B, H, Sk, Dh)),
            "wq": _w((lambda *s: torch.randn(*s, dtype=torch.bfloat16) * 3.2)(D, H * Dh) * (D ** -0.5)),
            "wo": _w((lambda *s: torch.randn(*s, dtype=torch.bfloat16) * 0.4)(H * Dh, D) * ((H * Dh) ** -0.5)),
        }
    _A_in = _A_setup()

    def _B_setup():
        B, S, D, F = 1, 1, 640, 1536
        return {
            "x": _w((lambda *s: torch.randn(*s, dtype=torch.bfloat16) * 0.05)(B, S, D)),
            "w_gate": _w((lambda *s: torch.randn(*s, dtype=torch.bfloat16) * 0.1)(D, F)),
            "w_up": _w((lambda *s: torch.randn(*s, dtype=torch.bfloat16) * 0.05)(D, F)),
            "w_down": _w((lambda *s: torch.randn(*s, dtype=torch.bfloat16) * 0.05)(F, D)),
        }
    _B_in = _B_setup()

    return {
        "A_x": _A_in["x"],
        "A_k_cache": _A_in["k_cache"],
        "A_v_cache": _A_in["v_cache"],
        "A_wq": _A_in["wq"],
        "A_wo": _A_in["wo"],
        "B_x": _B_in["x"],
        "B_w_gate": _B_in["w_gate"],
        "B_w_up": _B_in["w_up"],
        "B_w_down": _B_in["w_down"],
    }

def reference(A_x, A_k_cache, A_v_cache, A_wq, A_wo, B_x, B_w_gate, B_w_up, B_w_down):
    def _A_ref(x, k_cache, v_cache, wq, wo):
        B, Sq, D = x.shape
        H, Dh = 32, 192
        q = (lambda x, *d: x.permute(*d))((x @ wq).reshape(B, Sq, H, Dh), 0, 2, 1, 3)
        scores = torch.einsum("bhqd,bhkd->bhqk", q, k_cache) * (Dh ** -0.5)
        p = _softmax(scores, axis=-1)
        o = torch.einsum("bhqk,bhkd->bhqd", p, v_cache)
        return (lambda x, *d: x.permute(*d))(o, 0, 2, 1, 3).reshape(B, Sq, H * Dh) @ wo

    def _B_ref(x, w_gate, w_up, w_down):
        g = torch.einsum("bsd,df->bsf", x, w_gate)
        u = torch.einsum("bsd,df->bsf", x, w_up)
        h = _sigmoid(g) * u
        return torch.einsum("bsf,fd->bsd", h, w_down)

    x = A_x
    h = x + _A_ref(_layernorm(x, axis=-1), A_k_cache, A_v_cache, A_wq, A_wo)
    h2 = h + _B_ref(_layernorm(h, axis=-1), B_w_gate, B_w_up, B_w_down)
    return h2
```

```asm
; @launch grid=(256,1,1) block=(512,1,1) lds=62976
.amdgcn_target "amdgcn-amd-amdhsa--gfx950"
.text
.globl sequential_preLN__mha_block_cached__glu_gated_glu__decode_kernel
.p2align 8
.type sequential_preLN__mha_block_cached__glu_gated_glu__decode_kernel,@function
sequential_preLN__mha_block_cached__glu_gated_glu__decode_kernel:
  s_cmp_ge_u32 s2, 256
  s_cbranch_scc1 L_end
  s_load_dwordx16 s[4:19], s[0:1], 0
  s_load_dwordx8 s[20:27], s[0:1], 64
  s_lshr_b32 s29, s2, 3
  s_and_b32 s30, s2, 7
  v_lshrrev_b32 v2, 6, v0
  v_and_b32 v1, 63, v0
  v_readfirstlane_b32 s31, v2
  s_mov_b32 s33, 0x3fb8aa3b
  s_mov_b32 s34, 0x3d93cd3a
  s_mov_b32 s35, 0xffff0000
  v_lshrrev_b32 v2, 3, v1
  v_and_b32 v3, 7, v1
  s_cmp_lt_u32 s31, 4
  s_cbranch_scc1 L_stream
  s_setprio 3
  s_sub_u32 s31, s31, 4
  s_getreg_b32 s68, hwreg(HW_REG_XCC_ID, 0, 4)
  v_lshlrev_b32 v80, 4, v1
  v_mul_u32_u24 v19, 12288, v2
  v_lshl_add_u32 v19, v3, 4, v19
  s_mul_i32 s52, s30, 80
  s_lshl_b32 s53, s31, 3
  s_add_u32 s52, s52, s53
  v_add_u32 v81, s52, v2
  v_lshlrev_b32 v81, 1, v81
  s_waitcnt lgkmcnt(0)
  s_load_dword s28, s[26:27], 0
  s_mov_b32 s36, s4
  s_mov_b32 s37, s5
  s_and_b32 s37, s37, 0xffff
  s_mov_b32 s38, 1280
  s_mov_b32 s39, 0x20000
  buffer_load_dwordx4 v[8:11], v80, s[36:39], 0 offen
  buffer_load_dwordx4 v[12:15], v80, s[36:39], 0 offen offset:1024
  buffer_load_ushort v16, v81, s[36:39], 0 offen offset:0
  buffer_load_ushort v17, v81, s[36:39], 0 offen offset:64
  buffer_load_ushort v18, v81, s[36:39], 0 offen offset:128
  s_mul_i32 s52, s29, 384
  s_mul_i32 s53, s30, 983040
  s_add_u32 s52, s52, s53
  s_add_u32 s40, s10, s52
  s_addc_u32 s41, s11, 0
  s_and_b32 s41, s41, 0xffff
  s_sub_u32 s42, 7864320, s52
  s_mov_b32 s43, 0x20000
  s_add_u32 s52, s31, 0
  s_mul_i32 s52, s52, 98304
  buffer_load_dwordx4 v[20:23], v19, s[40:43], s52 offen offset:0 nt
  buffer_load_dwordx4 v[24:27], v19, s[40:43], s52 offen offset:128 nt
  buffer_load_dwordx4 v[28:31], v19, s[40:43], s52 offen offset:256 nt
  s_add_u32 s52, s31, 4
  s_mul_i32 s52, s52, 98304
  buffer_load_dwordx4 v[32:35], v19, s[40:43], s52 offen offset:0 nt
  buffer_load_dwordx4 v[36:39], v19, s[40:43], s52 offen offset:128 nt
  buffer_load_dwordx4 v[40:43], v19, s[40:43], s52 offen offset:256 nt
  s_add_u32 s52, s31, 8
  s_mul_i32 s52, s52, 98304
  s_cmp_lt_u32 s31, 2
  s_cselect_b32 s52, s52, 0x40000000
  buffer_load_dwordx4 v[44:47], v19, s[40:43], s52 offen offset:0 nt
  buffer_load_dwordx4 v[48:51], v19, s[40:43], s52 offen offset:128 nt
  buffer_load_dwordx4 v[52:55], v19, s[40:43], s52 offen offset:256 nt
  s_barrier
  s_mov_b32 s44, s26
  s_mov_b32 s45, s27
  s_and_b32 s45, s45, 0xffff
  s_mov_b32 s46, 4194304
  s_mov_b32 s47, 0x20000
  s_cmp_lg_u32 s31, 3
  s_cbranch_scc1 SK_1
  v_lshlrev_b32 v82, 3, v1
  v_mov_b32 v84, -1
  v_mov_b32 v85, -1
  ds_write_b64 v82, v[84:85] offset:13072
  v_mov_b32 v82, 0
  v_mov_b32 v84, 0
  v_mov_b32 v85, 0
  ds_write_b64 v82, v[84:85] offset:13056
  ds_write_b64 v82, v[84:85] offset:13064
SK_1:
  s_or_b32 s52, s30, s31
  s_cmp_lg_u32 s52, 0
  s_cbranch_scc1 SK_2
  s_mul_i32 s52, s29, 4352
  s_add_u32 s52, s52, 65536
  v_mov_b32 v82, 0
  v_mov_b32 v83, s52
  buffer_store_dword v82, v83, s[44:47], 0 offen sc0 sc1
  s_waitcnt vmcnt(10)
  s_branch SK_2_b
SK_2:
  s_waitcnt vmcnt(9)
SK_2_b:
  v_lshlrev_b32 v88, 16, v8
  v_and_b32 v89, s35, v8
  v_lshlrev_b32 v96, 16, v12
  v_and_b32 v97, s35, v12
  v_lshlrev_b32 v90, 16, v9
  v_and_b32 v91, s35, v9
  v_lshlrev_b32 v98, 16, v13
  v_and_b32 v99, s35, v13
  v_lshlrev_b32 v92, 16, v10
  v_and_b32 v93, s35, v10
  v_lshlrev_b32 v100, 16, v14
  v_and_b32 v101, s35, v14
  v_lshlrev_b32 v94, 16, v11
  v_and_b32 v95, s35, v11
  v_lshlrev_b32 v102, 16, v15
  v_and_b32 v103, s35, v15
  v_cmp_gt_u32 s[62:63], 16, v1
  v_add_f32 v80, v88, v89
  v_add_f32 v80, v80, v90
  v_add_f32 v80, v80, v91
  v_add_f32 v80, v80, v92
  v_add_f32 v80, v80, v93
  v_add_f32 v80, v80, v94
  v_add_f32 v80, v80, v95
  v_add_f32 v80, v80, v96
  v_add_f32 v80, v80, v97
  v_add_f32 v80, v80, v98
  v_add_f32 v80, v80, v99
  v_add_f32 v80, v80, v100
  v_add_f32 v80, v80, v101
  v_add_f32 v80, v80, v102
  v_add_f32 v80, v80, v103
  s_nop 1
  v_add_f32_dpp v80, v80, v80 quad_perm:[1,0,3,2] row_mask:0xf bank_mask:0xf
  s_nop 1
  v_add_f32_dpp v80, v80, v80 quad_perm:[2,3,0,1] row_mask:0xf bank_mask:0xf
  s_nop 1
  v_add_f32_dpp v80, v80, v80 row_half_mirror row_mask:0xf bank_mask:0xf
  s_nop 1
  v_add_f32_dpp v80, v80, v80 row_ror:8 row_mask:0xf bank_mask:0xf
  v_mov_b32 v81, v80
  s_nop 1
  v_permlane16_swap_b32 v80, v81
  v_add_f32 v80, v80, v81
  v_mov_b32 v81, v80
  s_nop 1
  v_permlane32_swap_b32 v80, v81
  v_add_f32 v80, v80, v81
  v_mul_f32 v80, 0x3acccccd, v80
  v_sub_f32 v81, v88, v80
  v_mul_f32 v83, v81, v81
  v_sub_f32 v81, v89, v80
  v_fma_f32 v83, v81, v81, v83
  v_sub_f32 v81, v90, v80
  v_fma_f32 v83, v81, v81, v83
  v_sub_f32 v81, v91, v80
  v_fma_f32 v83, v81, v81, v83
  v_sub_f32 v81, v92, v80
  v_fma_f32 v83, v81, v81, v83
  v_sub_f32 v81, v93, v80
  v_fma_f32 v83, v81, v81, v83
  v_sub_f32 v81, v94, v80
  v_fma_f32 v83, v81, v81, v83
  v_sub_f32 v81, v95, v80
  v_fma_f32 v83, v81, v81, v83
  v_sub_f32 v81, v96, v80
  v_cndmask_b32 v81, 0, v81, s[62:63]
  v_fma_f32 v83, v81, v81, v83
  v_sub_f32 v81, v97, v80
  v_cndmask_b32 v81, 0, v81, s[62:63]
  v_fma_f32 v83, v81, v81, v83
  v_sub_f32 v81, v98, v80
  v_cndmask_b32 v81, 0, v81, s[62:63]
  v_fma_f32 v83, v81, v81, v83
  v_sub_f32 v81, v99, v80
  v_cndmask_b32 v81, 0, v81, s[62:63]
  v_fma_f32 v83, v81, v81, v83
  v_sub_f32 v81, v100, v80
  v_cndmask_b32 v81, 0, v81, s[62:63]
  v_fma_f32 v83, v81, v81, v83
  v_sub_f32 v81, v101, v80
  v_cndmask_b32 v81, 0, v81, s[62:63]
  v_fma_f32 v83, v81, v81, v83
  v_sub_f32 v81, v102, v80
  v_cndmask_b32 v81, 0, v81, s[62:63]
  v_fma_f32 v83, v81, v81, v83
  v_sub_f32 v81, v103, v80
  v_cndmask_b32 v81, 0, v81, s[62:63]
  v_fma_f32 v83, v81, v81, v83
  s_nop 1
  v_add_f32_dpp v83, v83, v83 quad_perm:[1,0,3,2] row_mask:0xf bank_mask:0xf
  s_nop 1
  v_add_f32_dpp v83, v83, v83 quad_perm:[2,3,0,1] row_mask:0xf bank_mask:0xf
  s_nop 1
  v_add_f32_dpp v83, v83, v83 row_half_mirror row_mask:0xf bank_mask:0xf
  s_nop 1
  v_add_f32_dpp v83, v83, v83 row_ror:8 row_mask:0xf bank_mask:0xf
  v_mov_b32 v81, v83
  s_nop 1
  v_permlane16_swap_b32 v83, v81
  v_add_f32 v83, v83, v81
  v_mov_b32 v81, v83
  s_nop 1
  v_permlane32_swap_b32 v83, v81
  v_add_f32 v83, v83, v81
  v_mul_f32 v83, 0x3acccccd, v83
  v_cvt_pk_bf16_f32 v83, v83, v83
  v_and_b32 v83, 0xffff0000, v83
  v_add_f32 v83, 0x3727c5ac, v83
  v_cvt_pk_bf16_f32 v83, v83, v83
  v_and_b32 v83, 0xffff0000, v83
  v_sqrt_f32 v83, v83
  s_nop 0
  v_cvt_pk_bf16_f32 v83, v83, v83
  v_and_b32 v83, 0xffff0000, v83
  v_rcp_f32 v83, v83
  v_cvt_pk_bf16_f32 v82, v80, v80
  v_and_b32 v82, 0xffff0000, v82
  v_mov_b32 v56, 0
  v_mov_b32 v57, 0
  v_mov_b32 v58, 0
  v_mov_b32 v59, 0
  v_mov_b32 v60, 0
  v_mov_b32 v61, 0
  v_mov_b32 v62, 0
  v_mov_b32 v63, 0
  v_mov_b32 v64, 0
  v_mov_b32 v65, 0
  v_mov_b32 v66, 0
  v_mov_b32 v67, 0
  v_mov_b32 v68, 0
  v_mov_b32 v69, 0
  v_mov_b32 v70, 0
  v_mov_b32 v71, 0
  v_mov_b32 v72, 0
  v_mov_b32 v73, 0
  v_mov_b32 v74, 0
  v_mov_b32 v75, 0
  v_mov_b32 v76, 0
  v_mov_b32 v77, 0
  v_mov_b32 v78, 0
  v_mov_b32 v79, 0
  v_lshlrev_b32 v16, 16, v16
  v_sub_f32 v16, v16, v82
  v_cvt_pk_bf16_f32 v16, v16, v16
  v_and_b32 v16, 0xffff0000, v16
  v_mul_f32 v16, v16, v83
  v_cvt_pk_bf16_f32 v108, v16, 0
  v_cvt_pk_bf16_f32 v109, 0, v16
  v_lshlrev_b32 v17, 16, v17
  v_sub_f32 v17, v17, v82
  v_cvt_pk_bf16_f32 v17, v17, v17
  v_and_b32 v17, 0xffff0000, v17
  v_mul_f32 v17, v17, v83
  v_cvt_pk_bf16_f32 v110, v17, 0
  v_cvt_pk_bf16_f32 v111, 0, v17
  v_lshlrev_b32 v18, 16, v18
  v_sub_f32 v18, v18, v82
  v_cvt_pk_bf16_f32 v18, v18, v18
  v_and_b32 v18, 0xffff0000, v18
  v_mul_f32 v18, v18, v83
  v_cvt_pk_bf16_f32 v112, v18, 0
  v_cvt_pk_bf16_f32 v113, 0, v18
  s_waitcnt vmcnt(0) lgkmcnt(0)
  s_mul_i32 s32, s28, 0x9E3779B1
  s_add_u32 s32, s32, 0x7F4A7C15
  v_dot2_f32_bf16 v56, v20, v108, v56
  v_dot2_f32_bf16 v57, v20, v109, v57
  v_dot2_f32_bf16 v58, v21, v108, v58
  v_dot2_f32_bf16 v59, v21, v109, v59
  v_dot2_f32_bf16 v60, v22, v108, v60
  v_dot2_f32_bf16 v61, v22, v109, v61
  v_dot2_f32_bf16 v62, v23, v108, v62
  v_dot2_f32_bf16 v63, v23, v109, v63
  v_dot2_f32_bf16 v64, v24, v108, v64
  v_dot2_f32_bf16 v65, v24, v109, v65
  v_dot2_f32_bf16 v66, v25, v108, v66
  v_dot2_f32_bf16 v67, v25, v109, v67
  v_dot2_f32_bf16 v68, v26, v108, v68
  v_dot2_f32_bf16 v69, v26, v109, v69
  v_dot2_f32_bf16 v70, v27, v108, v70
  v_dot2_f32_bf16 v71, v27, v109, v71
  v_dot2_f32_bf16 v72, v28, v108, v72
  v_dot2_f32_bf16 v73, v28, v109, v73
  v_dot2_f32_bf16 v74, v29, v108, v74
  v_dot2_f32_bf16 v75, v29, v109, v75
  v_dot2_f32_bf16 v76, v30, v108, v76
  v_dot2_f32_bf16 v77, v30, v109, v77
  v_dot2_f32_bf16 v78, v31, v108, v78
  v_dot2_f32_bf16 v79, v31, v109, v79
  v_dot2_f32_bf16 v56, v32, v110, v56
  v_dot2_f32_bf16 v57, v32, v111, v57
  v_dot2_f32_bf16 v58, v33, v110, v58
  v_dot2_f32_bf16 v59, v33, v111, v59
  v_dot2_f32_bf16 v60, v34, v110, v60
  v_dot2_f32_bf16 v61, v34, v111, v61
  v_dot2_f32_bf16 v62, v35, v110, v62
  v_dot2_f32_bf16 v63, v35, v111, v63
  v_dot2_f32_bf16 v64, v36, v110, v64
  v_dot2_f32_bf16 v65, v36, v111, v65
  v_dot2_f32_bf16 v66, v37, v110, v66
  v_dot2_f32_bf16 v67, v37, v111, v67
  v_dot2_f32_bf16 v68, v38, v110, v68
  v_dot2_f32_bf16 v69, v38, v111, v69
  v_dot2_f32_bf16 v70, v39, v110, v70
  v_dot2_f32_bf16 v71, v39, v111, v71
  v_dot2_f32_bf16 v72, v40, v110, v72
  v_dot2_f32_bf16 v73, v40, v111, v73
  v_dot2_f32_bf16 v74, v41, v110, v74
  v_dot2_f32_bf16 v75, v41, v111, v75
  v_dot2_f32_bf16 v76, v42, v110, v76
  v_dot2_f32_bf16 v77, v42, v111, v77
  v_dot2_f32_bf16 v78, v43, v110, v78
  v_dot2_f32_bf16 v79, v43, v111, v79
  v_dot2_f32_bf16 v56, v44, v112, v56
  v_dot2_f32_bf16 v57, v44, v113, v57
  v_dot2_f32_bf16 v58, v45, v112, v58
  v_dot2_f32_bf16 v59, v45, v113, v59
  v_dot2_f32_bf16 v60, v46, v112, v60
  v_dot2_f32_bf16 v61, v46, v113, v61
  v_dot2_f32_bf16 v62, v47, v112, v62
  v_dot2_f32_bf16 v63, v47, v113, v63
  v_dot2_f32_bf16 v64, v48, v112, v64
  v_dot2_f32_bf16 v65, v48, v113, v65
  v_dot2_f32_bf16 v66, v49, v112, v66
  v_dot2_f32_bf16 v67, v49, v113, v67
  v_dot2_f32_bf16 v68, v50, v112, v68
  v_dot2_f32_bf16 v69, v50, v113, v69
  v_dot2_f32_bf16 v70, v51, v112, v70
  v_dot2_f32_bf16 v71, v51, v113, v71
  v_dot2_f32_bf16 v72, v52, v112, v72
  v_dot2_f32_bf16 v73, v52, v113, v73
  v_dot2_f32_bf16 v74, v53, v112, v74
  v_dot2_f32_bf16 v75, v53, v113, v75
  v_dot2_f32_bf16 v76, v54, v112, v76
  v_dot2_f32_bf16 v77, v54, v113, v77
  v_dot2_f32_bf16 v78, v55, v112, v78
  v_dot2_f32_bf16 v79, v55, v113, v79
  s_nop 2
  v_permlane32_swap_b32 v56, v68
  v_permlane32_swap_b32 v57, v69
  v_permlane32_swap_b32 v58, v70
  v_permlane32_swap_b32 v59, v71
  v_permlane32_swap_b32 v60, v72
  v_permlane32_swap_b32 v61, v73
  v_permlane32_swap_b32 v62, v74
  v_permlane32_swap_b32 v63, v75
  v_permlane32_swap_b32 v64, v76
  v_permlane32_swap_b32 v65, v77
  v_permlane32_swap_b32 v66, v78
  v_permlane32_swap_b32 v67, v79
  v_add_f32 v56, v56, v68
  v_add_f32 v57, v57, v69
  v_add_f32 v58, v58, v70
  v_add_f32 v59, v59, v71
  v_add_f32 v60, v60, v72
  v_add_f32 v61, v61, v73
  v_add_f32 v62, v62, v74
  v_add_f32 v63, v63, v75
  v_add_f32 v64, v64, v76
  v_add_f32 v65, v65, v77
  v_add_f32 v66, v66, v78
  v_add_f32 v67, v67, v79
  s_nop 1
  v_permlane16_swap_b32 v56, v62
  v_permlane16_swap_b32 v57, v63
  v_permlane16_swap_b32 v58, v64
  v_permlane16_swap_b32 v59, v65
  v_permlane16_swap_b32 v60, v66
  v_permlane16_swap_b32 v61, v67
  v_add_f32 v56, v56, v62
  v_add_f32 v57, v57, v63
  v_add_f32 v58, v58, v64
  v_add_f32 v59, v59, v65
  v_add_f32 v60, v60, v66
  v_add_f32 v61, v61, v67
  s_nop 0
  v_add_f32_dpp v56, v56, v56 row_ror:8 row_mask:0xf bank_mask:0xf
  v_add_f32_dpp v57, v57, v57 row_ror:8 row_mask:0xf bank_mask:0xf
  v_add_f32_dpp v58, v58, v58 row_ror:8 row_mask:0xf bank_mask:0xf
  v_add_f32_dpp v59, v59, v59 row_ror:8 row_mask:0xf bank_mask:0xf
  v_add_f32_dpp v60, v60, v60 row_ror:8 row_mask:0xf bank_mask:0xf
  v_add_f32_dpp v61, v61, v61 row_ror:8 row_mask:0xf bank_mask:0xf
  v_lshrrev_b32 v80, 4, v1
  v_mul_u32_u24 v80, 192, v80
  v_lshl_add_u32 v80, v3, 2, v80
  s_mul_i32 s52, s31, 768
  v_add_u32 v80, s52, v80
  ds_write_b32 v80, v56 offset:0
  ds_write_b32 v80, v57 offset:32
  ds_write_b32 v80, v58 offset:64
  ds_write_b32 v80, v59 offset:96
  ds_write_b32 v80, v60 offset:128
  ds_write_b32 v80, v61 offset:160
  s_lshl_b32 s52, s31, 6
  v_add_u32 v4, s52, v1
  s_waitcnt lgkmcnt(0)
  s_barrier
  s_cmp_ge_u32 s31, 3
  s_cbranch_scc1 L_q_done
  v_lshlrev_b32 v80, 2, v4
  ds_read_b32 v81, v80 offset:0
  ds_read_b32 v82, v80 offset:768
  ds_read_b32 v83, v80 offset:1536
  ds_read_b32 v84, v80 offset:2304
  s_mul_i32 s52, s2, 1536
  s_add_u32 s52, s52, 262144
  v_lshlrev_b32 v85, 3, v4
  v_mov_b32 v87, s32
  s_waitcnt lgkmcnt(0)
  v_add_f32 v81, v81, v82
  v_add_f32 v83, v83, v84
  v_add_f32 v86, v81, v83
  buffer_store_dwordx2 v[86:87], v85, s[44:47], s52 offen sc0 sc1
  s_cmp_lg_u32 s31, 0
  s_cbranch_scc1 SK_3
  s_lshl_b32 s53, s30, 5
  s_add_u32 s53, s53, s29
  s_lshl_b32 s53, s53, 3
  s_add_u32 s53, s53, 32768
  v_mov_b32 v88, s68
  v_mov_b32 v89, s32
  v_mov_b32 v90, 0
  s_mov_b64 exec, 1
  buffer_store_dwordx2 v[88:89], v90, s[44:47], s53 offen sc0 sc1
  s_mov_b64 exec, -1
SK_3:
  s_mul_i32 s53, s29, 12288
  s_add_u32 s53, s53, 262144
  v_lshrrev_b32 v80, 6, v4
  v_lshlrev_b32 v80, 6, v80
  v_and_b32 v81, 7, v4
  v_lshl_add_u32 v80, v81, 3, v80
  v_bfe_u32 v81, v4, 3, 3
  v_add_u32 v5, v80, v81
  s_mov_b32 s61, 0
POLL_4:
  s_add_u32 s54, s53, 0
  buffer_load_dwordx2 v[20:21], v85, s[44:47], s54 offen sc0 sc1
  s_add_u32 s54, s53, 1536
  buffer_load_dwordx2 v[22:23], v85, s[44:47], s54 offen sc0 sc1
  s_add_u32 s54, s53, 3072
  buffer_load_dwordx2 v[24:25], v85, s[44:47], s54 offen sc0 sc1
  s_add_u32 s54, s53, 4608
  buffer_load_dwordx2 v[26:27], v85, s[44:47], s54 offen sc0 sc1
  s_add_u32 s54, s53, 6144
  buffer_load_dwordx2 v[28:29], v85, s[44:47], s54 offen sc0 sc1
  s_add_u32 s54, s53, 7680
  buffer_load_dwordx2 v[30:31], v85, s[44:47], s54 offen sc0 sc1
  s_add_u32 s54, s53, 9216
  buffer_load_dwordx2 v[32:33], v85, s[44:47], s54 offen sc0 sc1
  s_add_u32 s54, s53, 10752
  buffer_load_dwordx2 v[34:35], v85, s[44:47], s54 offen sc0 sc1
  s_waitcnt vmcnt(0)
  v_xor_b32 v88, s32, v21
  v_bitop3_b32 v88, v23, v88, s32 bitop3:0xde
  v_bitop3_b32 v88, v25, v88, s32 bitop3:0xde
  v_bitop3_b32 v88, v27, v88, s32 bitop3:0xde
  v_bitop3_b32 v88, v29, v88, s32 bitop3:0xde
  v_bitop3_b32 v88, v31, v88, s32 bitop3:0xde
  v_bitop3_b32 v88, v33, v88, s32 bitop3:0xde
  v_bitop3_b32 v88, v35, v88, s32 bitop3:0xde
  v_cmp_ne_u32 vcc, 0, v88
  s_nop 1
  s_cbranch_vccz PD_5
  s_add_u32 s61, s61, 1
  s_cmp_lt_u32 s61, 65536
  s_cbranch_scc1 POLL_4
  s_mov_b32 s52, 1
  s_branch L_timeout
PD_5:
  v_add_f32 v20, v20, v22
  v_add_f32 v24, v24, v26
  v_add_f32 v28, v28, v30
  v_add_f32 v32, v32, v34
  v_add_f32 v20, v20, v24
  v_add_f32 v28, v28, v32
  v_add_f32 v20, v20, v28
  v_cvt_pk_bf16_f32 v20, v20, v20
  v_lshlrev_b32 v80, 1, v5
  ds_write_b16 v80, v20 offset:3072
L_q_done:
  s_waitcnt lgkmcnt(0)
  s_barrier
  s_setprio 0
  v_and_b32 v7, 15, v1
  v_lshlrev_b32 v7, 3, v7
  v_lshrrev_b32 v8, 4, v1
  v_lshlrev_b32 v8, 4, v8
  s_mul_i32 s52, s29, 245760
  s_mul_i32 s53, s30, 128
  s_add_u32 s52, s52, s53
  s_lshl_b32 s53, s31, 5
  s_add_u32 s52, s52, s53
  s_add_u32 s40, s12, s52
  s_addc_u32 s41, s13, 0
  s_and_b32 s41, s41, 0xffff
  s_sub_u32 s42, 7864320, s52
  s_mov_b32 s43, 0x20000
  v_lshrrev_b32 v120, 1, v1
  v_mul_u32_u24 v120, 1280, v120
  v_and_b32 v121, 1, v1
  v_lshl_add_u32 v120, v121, 4, v120
  s_mul_i32 s69, s29, 5120
  s_mul_i32 s53, s30, 512
  s_add_u32 s69, s69, s53
  s_lshl_b32 s53, s31, 7
  s_add_u32 s69, s69, s53
  s_add_u32 s69, s69, 1703936
  s_mov_b32 s3, 0
  s_lshl_b32 s96, s30, 2
  s_sub_u32 s96, s29, s96
  s_and_b32 s96, s96, 31
  s_add_u32 s96, s96, 28
  s_and_b32 s96, s96, 31
  s_cmp_ge_u32 s96, 30
  s_cbranch_scc1 L_pf3
  s_cmp_ge_u32 s96, 24
  s_cbranch_scc1 L_pf5
  s_cmp_eq_u32 s31, 1
  s_cbranch_scc1 L_pf4
  s_branch L_pf_done
L_pf3:
  s_sub_u32 s15, s96, 30
  s_lshl_b32 s15, s15, 2
  s_add_u32 s15, s15, s31
  s_cmp_ge_u32 s30, 6
  s_cselect_b32 s52, 8, 4
  s_cmp_ge_u32 s15, s52
  s_cbranch_scc1 L_pf_done
  s_mov_b32 s3, 3
  s_mov_b32 s36, s4
  s_mov_b32 s37, s5
  s_and_b32 s37, s37, 0xffff
  s_mov_b32 s38, 1280
  s_mov_b32 s39, 0x20000
  s_lshr_b32 s53, s15, 2
  s_lshl_b32 s53, s53, 1
  s_add_u32 s53, s53, s30
  s_lshl_b32 s55, s53, 6
  s_and_b32 s53, s15, 3
  s_lshl_b32 s53, s53, 4
  s_add_u32 s55, s55, s53
  s_lshl_b32 s52, s55, 1
  v_lshrrev_b32 v121, 2, v7
  buffer_load_ushort v6, v121, s[36:39], s52 offen
  s_lshl_b32 s52, s55, 3
  s_add_u32 s18, s52, 1703936
  s_lshr_b32 s19, s52, 1
  s_add_u32 s19, s19, 1900544
  v_mul_u32_u24 v64, 320, v8
  v_add_u32 v64, v64, v7
  v_lshlrev_b32 v65, 9, v8
  v_lshrrev_b32 v122, 4, v7
  v_lshl_add_u32 v65, v122, 3, v65
  v_and_b32 v122, 1, v1
  v_lshl_add_u32 v65, v122, 12, v65
  s_branch L_pf_done
L_pf4:
  s_mov_b32 s3, 1
  s_lshr_b32 s52, s96, 3
  s_lshl_b32 s52, s52, 3
  s_add_u32 s52, s52, s30
  s_lshl_b32 s52, s52, 3
  s_and_b32 s53, s96, 7
  s_add_u32 s52, s52, s53
  s_lshl_b32 s52, s52, 4
  s_add_u32 s36, s16, s52
  s_addc_u32 s37, s17, 0
  s_and_b32 s37, s37, 0xffff
  s_sub_u32 s38, 1966080, s52
  s_mov_b32 s39, 0x20000
  s_add_u32 s40, s18, s52
  s_addc_u32 s41, s19, 0
  s_and_b32 s41, s41, 0xffff
  s_sub_u32 s42, 1966080, s52
  s_mov_b32 s43, 0x20000
  v_mul_u32_u24 v121, 3072, v1
  s_branch L_pf_done
L_pf5:
  s_cmp_lt_u32 s96, 28
  s_cbranch_scc1 T5_7
  s_lshl_b32 s52, s30, 1
  s_and_b32 s53, s96, 1
  s_add_u32 s52, s52, s53
  s_add_u32 s52, s52, 32
  s_branch T5_8
T5_7:
  s_lshl_b32 s52, s30, 2
  s_and_b32 s53, s96, 3
  s_add_u32 s52, s52, s53
T5_8:
  s_cmp_ge_u32 s52, 40
  s_cbranch_scc1 L_pf_done
  s_mov_b32 s3, 2
  s_lshl_b32 s52, s52, 5
  s_mul_i32 s53, s31, 491520
  s_add_u32 s52, s52, s53
  s_add_u32 s36, s20, s52
  s_addc_u32 s37, s21, 0
  s_and_b32 s37, s37, 0xffff
  s_sub_u32 s38, 1966080, s52
  s_mov_b32 s39, 0x20000
L_pf_done:
  s_mul_i32 s52, s31, 12288
  s_add_u32 s52, s52, 13824
  v_lshlrev_b32 v124, 4, v1
  v_add_u32 v124, s52, v124
  v_lshlrev_b32 v125, 4, v8
  v_lshrrev_b32 v126, 2, v7
  v_add_u32 v125, v125, v126
  v_add_u32 v125, s52, v125
  v_lshlrev_b32 v126, 5, v1
  v_add_u32 v126, s52, v126
  s_waitcnt vmcnt(0)
  s_cmp_eq_u32 s3, 2
  s_cbranch_scc1 L_st5
  s_cmp_lg_u32 s3, 1
  s_cbranch_scc1 L_st_done
  s_branch L_st_done
L_st5:
L_st_done:
  v_lshrrev_b32 v9, 4, v1
  v_lshlrev_b32 v9, 3, v9
  v_bfe_u32 v10, v1, 2, 2
  v_add_u32 v9, v9, v10
  v_and_b32 v10, 3, v1
  v_bfe_u32 v11, v9, 3, 1
  v_xor_b32 v11, v11, v9
  v_and_b32 v11, 3, v11
  v_lshlrev_b32 v11, 1, v11
  v_lshrrev_b32 v12, 1, v10
  s_lshl_b32 s52, s31, 1
  v_add_u32 v12, s52, v12
  v_xor_b32 v12, v12, v11
  v_lshlrev_b32 v12, 4, v12
  v_lshl_add_u32 v120, v9, 7, v12
  v_and_b32 v12, 1, v10
  v_lshl_add_u32 v120, v12, 3, v120
  v_add_u32 v120, 13824, v120
  v_lshlrev_b32 v121, 4, v9
  v_and_b32 v11, 1, v1
  v_lshl_add_u32 v121, v11, 3, v121
  v_bfe_u32 v11, v1, 1, 1
  v_mul_u32_u24 v11, 10240, v11
  v_add_u32 v121, v121, v11
  v_add_u32 v121, 13824, v121
  v_lshlrev_b32 v122, 5, v9
  v_lshl_add_u32 v122, v10, 3, v122
  s_mul_i32 s52, s31, 12288
  s_add_u32 s52, s52, 13824
  v_add_u32 v122, s52, v122
  s_setprio 3
  s_mov_b32 s67, 0
  v_and_b32 v80, 31, v1
  v_lshlrev_b32 v80, 3, v80
  s_lshl_b32 s53, s30, 8
  s_add_u32 s53, s53, 32768
  s_mov_b32 s61, 0
POLL_9:
  buffer_load_dwordx2 v[82:83], v80, s[44:47], s53 offen sc0 sc1
  s_waitcnt vmcnt(0)
  v_xor_b32 v84, s32, v83
  v_cmp_ne_u32 vcc, 0, v84
  s_nop 1
  s_cbranch_vccz PD_10
  s_add_u32 s61, s61, 1
  s_cmp_lt_u32 s61, 65536
  s_cbranch_scc1 POLL_9
  s_mov_b32 s52, 8
  s_branch L_timeout
PD_10:
  v_cmp_ne_u32 vcc, s68, v82
  s_nop 1
  s_cmp_eq_u64 vcc, 0
  s_cselect_b32 s67, 1, 0
  s_mov_b32 s64, 0x3f803f80
  s_mov_b32 s65, 0xbfb8aa3b
  s_cmp_lg_u32 s31, 3
  s_cbranch_scc1 SRV_11_e
  s_mul_i32 s54, s29, 4352
  s_add_u32 s54, s54, 65536
  s_add_u32 s48, s26, s54
  s_addc_u32 s49, s27, 0
  s_and_b32 s49, s49, 0xffff
  s_mov_b32 s50, 4
  s_mov_b32 s51, 0x20000
  s_mov_b32 s53, 24
  s_mov_b32 s55, 13072
  s_mov_b32 s54, 4
  v_mov_b32 v84, 0
  s_mov_b32 s61, 0
SRV_11:
  ds_read_b128 v[80:83], v84 offset:13056
  s_add_u32 s61, s61, 1
  s_cmp_ge_u32 s61, 1048576
  s_mov_b32 s52, 6
  s_cbranch_scc1 L_timeout
  s_waitcnt lgkmcnt(0)
  v_max3_u32 v80, v80, v81, v82
  v_max_u32 v80, v80, v83
  s_nop 0
  v_readfirstlane_b32 s52, v80
  s_cmp_lt_u32 s52, s53
  s_cbranch_scc1 SRV_11
  s_lshl_b32 s56, s54, 2
  v_mov_b32 v80, s56
  s_mov_b64 exec, 1
  buffer_atomic_add v80, off, s[48:51], 0 sc0 sc1
  v_mov_b32 v81, s55
  s_waitcnt vmcnt(0)
  v_lshlrev_b32 v82, 3, v80
  v_or_b32 v82, s54, v82
  ds_write_b32 v81, v82
  v_readfirstlane_b32 s52, v80
  s_add_u32 s53, s53, 1
  s_add_u32 s55, s55, 4
  s_add_u32 s52, s52, s56
  s_cmp_ge_u32 s52, 768
  s_cselect_b32 s54, 2, 4
  s_cmp_ge_u32 s52, 768
  s_cselect_b32 s54, 1, s54
  s_mov_b64 exec, -1
  s_cmp_lt_u32 s52, 768
  s_cbranch_scc1 SRV_11
  v_mov_b32 v81, s55
  v_mov_b32 v82, 6148
  ds_write_b32 v81, v82
  s_waitcnt lgkmcnt(0)
SRV_11_e:
  s_mov_b32 s48, s26
  s_mov_b32 s49, s27
  s_and_b32 s49, s49, 0xffff
  s_mov_b32 s50, 4194304
  s_mov_b32 s51, 0x20000
  s_mul_i32 s53, s29, 12288
  s_add_u32 s53, s53, 1048576
  s_xor_b32 s52, s30, 1
  s_mul_i32 s52, s52, 1536
  s_add_u32 s4, s53, s52
  s_xor_b32 s52, s30, 2
  s_mul_i32 s52, s52, 1536
  s_add_u32 s5, s53, s52
  s_xor_b32 s52, s30, 3
  s_mul_i32 s52, s52, 1536
  s_add_u32 s6, s53, s52
  s_xor_b32 s52, s30, 4
  s_mul_i32 s52, s52, 1536
  s_add_u32 s7, s53, s52
  s_xor_b32 s52, s30, 5
  s_mul_i32 s52, s52, 1536
  s_add_u32 s8, s53, s52
  s_xor_b32 s52, s30, 6
  s_mul_i32 s52, s52, 1536
  s_add_u32 s9, s53, s52
  s_xor_b32 s52, s30, 7
  s_mul_i32 s52, s52, 1536
  s_add_u32 s10, s53, s52
  s_barrier
L_tail:
  s_cmp_ge_u32 s31, 3
  s_cbranch_scc1 L_s2_w3
  v_mov_b32 v80, 0
  ds_read_b128 v[16:19], v80 offset:7168
  ds_read_b128 v[20:23], v80 offset:7184
  v_lshlrev_b32 v81, 2, v4
  ds_read_b32 v24, v81 offset:4096
  ds_read_b32 v25, v81 offset:4864
  ds_read_b32 v26, v81 offset:5632
  ds_read_b32 v27, v81 offset:6400
  v_lshlrev_b32 v81, 3, v4
  s_mul_i32 s52, s2, 1536
  s_add_u32 s52, s52, 1048576
  s_lshl_b32 s56, s2, 4
  s_add_u32 s56, s56, 1572864
  s_mul_i32 s53, s29, 12288
  s_add_u32 s53, s53, 1048576
  s_lshl_b32 s55, s29, 7
  s_add_u32 s55, s55, 1572864
  v_and_b32 v93, 7, v1
  v_xor_b32 v93, s30, v93
  v_lshlrev_b32 v93, 4, v93
  s_waitcnt lgkmcnt(0)
  v_max3_f32 v82, v16, v18, v20
  v_max_f32 v82, v82, v22
  v_sub_f32 v16, v16, v82
  v_sub_f32 v18, v18, v82
  v_sub_f32 v20, v20, v82
  v_sub_f32 v22, v22, v82
  v_mul_f32 v16, s33, v16
  v_mul_f32 v18, s33, v18
  v_mul_f32 v20, s33, v20
  v_mul_f32 v22, s33, v22
  v_exp_f32 v16, v16
  v_exp_f32 v18, v18
  v_exp_f32 v20, v20
  v_exp_f32 v22, v22
  v_mov_b32 v85, s32
  v_mul_f32 v84, v16, v24
  v_mul_f32 v86, v16, v17
  v_fma_f32 v84, v18, v25, v84
  v_fma_f32 v86, v18, v19, v86
  v_fma_f32 v84, v20, v26, v84
  v_fma_f32 v86, v20, v21, v86
  v_fma_f32 v84, v22, v27, v84
  v_fma_f32 v86, v22, v23, v86
  buffer_store_dwordx2 v[84:85], v81, s[48:51], s52 offen sc0 sc1
  v_mov_b32 v88, v82
  v_mov_b32 v89, s32
  v_mov_b32 v90, v86
  v_mov_b32 v91, s32
  v_mov_b32 v92, 0
  s_cmp_lg_u32 s31, 0
  s_cbranch_scc1 SK_12
  s_mov_b64 exec, 1
  buffer_store_dwordx4 v[88:91], v92, s[48:51], s56 offen sc0 sc1
  s_mov_b64 exec, -1
SK_12:
  s_cmp_eq_u32 s67, 0
  s_cbranch_scc1 SK_13
  s_not_b32 s57, s32
  v_mov_b32 v100, 0
  v_mov_b32 v101, s57
  s_mov_b64 exec, 0xffff
  buffer_store_dwordx2 v[100:101], v7, s[44:47], s69 offen
  s_cmp_lt_u32 s30, 6
  s_cbranch_scc1 SK_14
  buffer_store_dwordx2 v[100:101], v7, s[44:47], s69 offen offset:1024
SK_14:
  s_mov_b64 exec, -1
SK_13:
  s_barrier
  s_cmp_lg_u32 s3, 3
  s_cbranch_scc1 SK_15
  s_add_u32 s54, s18, 0
  buffer_load_dwordx2 v[48:49], v64, s[44:47], s54 offen sc0 sc1
  s_add_u32 s54, s18, 20480
  buffer_load_dwordx2 v[50:51], v64, s[44:47], s54 offen sc0 sc1
  s_add_u32 s54, s18, 40960
  buffer_load_dwordx2 v[52:53], v64, s[44:47], s54 offen sc0 sc1
  s_add_u32 s54, s18, 61440
  buffer_load_dwordx2 v[54:55], v64, s[44:47], s54 offen sc0 sc1
  s_add_u32 s54, s18, 81920
  buffer_load_dwordx2 v[56:57], v64, s[44:47], s54 offen sc0 sc1
  s_add_u32 s54, s18, 102400
  buffer_load_dwordx2 v[58:59], v64, s[44:47], s54 offen sc0 sc1
  s_add_u32 s54, s18, 122880
  buffer_load_dwordx2 v[60:61], v64, s[44:47], s54 offen sc0 sc1
  s_add_u32 s54, s18, 143360
  buffer_load_dwordx2 v[62:63], v64, s[44:47], s54 offen sc0 sc1
SK_15:
  s_mov_b32 s14, 0
  v_mov_b32 v32, v82
  v_mov_b32 v33, s32
  v_mov_b32 v34, v86
  v_mov_b32 v35, s32
  s_mov_b32 s61, 0
POLL_16:
  buffer_load_dwordx2 v[18:19], v81, s[44:47], s4 offen sc0 sc1
  buffer_load_dwordx2 v[20:21], v81, s[44:47], s5 offen sc0 sc1
  buffer_load_dwordx2 v[22:23], v81, s[44:47], s6 offen sc0 sc1
  buffer_load_dwordx2 v[24:25], v81, s[44:47], s7 offen sc0 sc1
  buffer_load_dwordx2 v[26:27], v81, s[44:47], s8 offen sc0 sc1
  buffer_load_dwordx2 v[28:29], v81, s[44:47], s9 offen sc0 sc1
  buffer_load_dwordx2 v[30:31], v81, s[44:47], s10 offen sc0 sc1
  s_mov_b32 exec_lo, 0xfefefefe
  s_mov_b32 exec_hi, 0xfefefefe
  buffer_load_dwordx4 v[32:35], v93, s[44:47], s55 offen sc0 sc1
  s_mov_b64 exec, -1
  s_cmp_lg_u32 s14, 0
  s_cbranch_scc1 FI_17
  v_mov_b32 v99, 0
  ds_read_b128 v[100:103], v99 offset:13552
  s_waitcnt lgkmcnt(0)
  v_or_b32 v100, v100, v101
  v_or3_b32 v100, v100, v102, v103
  s_nop 0
  v_readfirstlane_b32 s57, v100
  s_cmp_lg_u32 s57, 0
  s_cbranch_scc1 FI_17
  ds_read_b64_tr_b16 v[128:129], v120 offset:0
  ds_read_b64_tr_b16 v[130:131], v120 offset:512
  ds_read_b64_tr_b16 v[132:133], v120 offset:4096
  ds_read_b64_tr_b16 v[134:135], v120 offset:4608
  ds_read_b64_tr_b16 v[136:137], v120 offset:8192
  ds_read_b64_tr_b16 v[138:139], v120 offset:8704
  ds_read_b64_tr_b16 v[140:141], v120 offset:12288
  ds_read_b64_tr_b16 v[142:143], v120 offset:12800
  ds_read_b64_tr_b16 v[144:145], v120 offset:16384
  ds_read_b64_tr_b16 v[146:147], v120 offset:16896
  ds_read_b64_tr_b16 v[148:149], v120 offset:20480
  ds_read_b64_tr_b16 v[150:151], v120 offset:20992
  s_cmp_lt_u32 s30, 6
  s_cbranch_scc1 SK_18
  ds_read_b64_tr_b16 v[152:153], v120 offset:24576
  ds_read_b64_tr_b16 v[154:155], v120 offset:25088
  ds_read_b64_tr_b16 v[156:157], v120 offset:28672
  ds_read_b64_tr_b16 v[158:159], v120 offset:29184
  ds_read_b64_tr_b16 v[160:161], v120 offset:32768
  ds_read_b64_tr_b16 v[162:163], v120 offset:33280
  ds_read_b64_tr_b16 v[164:165], v120 offset:36864
  ds_read_b64_tr_b16 v[166:167], v120 offset:37376
  ds_read_b64_tr_b16 v[168:169], v120 offset:40960
  ds_read_b64_tr_b16 v[170:171], v120 offset:41472
  ds_read_b64_tr_b16 v[172:173], v120 offset:45056
  ds_read_b64_tr_b16 v[174:175], v120 offset:45568
SK_18:
  s_mov_b32 s14, 1
FI_17:
  s_waitcnt vmcnt(0)
  v_xor_b32 v94, s32, v33
  v_bitop3_b32 v94, v35, v94, s32 bitop3:0xde
  v_bitop3_b32 v94, v19, v94, s32 bitop3:0xde
  v_bitop3_b32 v94, v21, v94, s32 bitop3:0xde
  v_bitop3_b32 v94, v23, v94, s32 bitop3:0xde
  v_bitop3_b32 v94, v25, v94, s32 bitop3:0xde
  v_bitop3_b32 v94, v27, v94, s32 bitop3:0xde
  v_bitop3_b32 v94, v29, v94, s32 bitop3:0xde
  v_bitop3_b32 v94, v31, v94, s32 bitop3:0xde
  v_cmp_ne_u32 vcc, 0, v94
  s_nop 1
  s_cbranch_vccz PD_19
  s_add_u32 s61, s61, 1
  s_cmp_lt_u32 s61, 65536
  s_cbranch_scc1 POLL_16
  s_mov_b32 s52, 2
  s_branch L_timeout
PD_19:
  s_cmp_lg_u32 s14, 0
  s_cbranch_scc1 FI_20
  v_mov_b32 v99, 0
  ds_read_b128 v[100:103], v99 offset:13552
  s_mov_b32 s61, 0
FW_21:
  s_waitcnt lgkmcnt(0)
  v_or_b32 v100, v100, v101
  v_or3_b32 v100, v100, v102, v103
  s_nop 0
  v_readfirstlane_b32 s57, v100
  s_cmp_eq_u32 s57, 0
  s_cbranch_scc1 FW_22
  ds_read_b128 v[100:103], v99 offset:13552
  s_add_u32 s61, s61, 1
  s_cmp_lt_u32 s61, 1048576
  s_cbranch_scc1 FW_21
  s_mov_b32 s52, 14
  s_branch L_timeout
FW_22:
  ds_read_b64_tr_b16 v[128:129], v120 offset:0
  ds_read_b64_tr_b16 v[130:131], v120 offset:512
  ds_read_b64_tr_b16 v[132:133], v120 offset:4096
  ds_read_b64_tr_b16 v[134:135], v120 offset:4608
  ds_read_b64_tr_b16 v[136:137], v120 offset:8192
  ds_read_b64_tr_b16 v[138:139], v120 offset:8704
  ds_read_b64_tr_b16 v[140:141], v120 offset:12288
  ds_read_b64_tr_b16 v[142:143], v120 offset:12800
  ds_read_b64_tr_b16 v[144:145], v120 offset:16384
  ds_read_b64_tr_b16 v[146:147], v120 offset:16896
  ds_read_b64_tr_b16 v[148:149], v120 offset:20480
  ds_read_b64_tr_b16 v[150:151], v120 offset:20992
  s_cmp_lt_u32 s30, 6
  s_cbranch_scc1 SK_23
  ds_read_b64_tr_b16 v[152:153], v120 offset:24576
  ds_read_b64_tr_b16 v[154:155], v120 offset:25088
  ds_read_b64_tr_b16 v[156:157], v120 offset:28672
  ds_read_b64_tr_b16 v[158:159], v120 offset:29184
  ds_read_b64_tr_b16 v[160:161], v120 offset:32768
  ds_read_b64_tr_b16 v[162:163], v120 offset:33280
  ds_read_b64_tr_b16 v[164:165], v120 offset:36864
  ds_read_b64_tr_b16 v[166:167], v120 offset:37376
  ds_read_b64_tr_b16 v[168:169], v120 offset:40960
  ds_read_b64_tr_b16 v[170:171], v120 offset:41472
  ds_read_b64_tr_b16 v[172:173], v120 offset:45056
  ds_read_b64_tr_b16 v[174:175], v120 offset:45568
SK_23:
FI_20:
  v_max_f32_dpp v82, v32, v32 quad_perm:[1,0,3,2] row_mask:0xf bank_mask:0xf
  s_nop 1
  v_max_f32_dpp v82, v82, v82 quad_perm:[2,3,0,1] row_mask:0xf bank_mask:0xf
  s_nop 1
  v_max_f32_dpp v82, v82, v82 row_half_mirror row_mask:0xf bank_mask:0xf
  v_sub_f32 v32, v32, v82
  v_mul_f32 v32, s33, v32
  v_exp_f32 v32, v32
  s_nop 0
  v_mul_f32 v86, v32, v34
  s_nop 1
  v_add_f32_dpp v86, v86, v86 quad_perm:[1,0,3,2] row_mask:0xf bank_mask:0xf
  s_nop 1
  v_add_f32_dpp v86, v86, v86 quad_perm:[2,3,0,1] row_mask:0xf bank_mask:0xf
  s_nop 1
  v_add_f32_dpp v86, v86, v86 row_half_mirror row_mask:0xf bank_mask:0xf
  v_rcp_f32 v86, v86
  v_lshlrev_b32 v80, 1, v5
  v_mul_f32 v86, v32, v86
  s_nop 0
  v_readlane_b32 s4, v86, 0
  v_readlane_b32 s5, v86, 1
  v_readlane_b32 s6, v86, 2
  v_readlane_b32 s7, v86, 3
  v_readlane_b32 s8, v86, 4
  v_readlane_b32 s9, v86, 5
  v_readlane_b32 s10, v86, 6
  v_readlane_b32 s11, v86, 7
  v_mul_f32 v84, s4, v84
  v_mul_f32 v85, s5, v18
  v_fma_f32 v84, s6, v20, v84
  v_fma_f32 v85, s7, v22, v85
  v_fma_f32 v84, s8, v24, v84
  v_fma_f32 v85, s9, v26, v85
  v_fma_f32 v84, s10, v28, v84
  v_fma_f32 v85, s11, v30, v85
  v_add_f32 v84, v84, v85
  v_cvt_pk_bf16_f32 v84, v84, v84
  ds_write_b16 v80, v84 offset:7424
  s_branch L_s2_gemv
L_s2_w3:
  s_cmp_eq_u32 s67, 0
  s_cbranch_scc1 SK_24
  s_not_b32 s57, s32
  v_mov_b32 v100, 0
  v_mov_b32 v101, s57
  s_mov_b64 exec, 0xffff
  buffer_store_dwordx2 v[100:101], v7, s[44:47], s69 offen
  s_cmp_lt_u32 s30, 6
  s_cbranch_scc1 SK_25
  buffer_store_dwordx2 v[100:101], v7, s[44:47], s69 offen offset:1024
SK_25:
  s_mov_b64 exec, -1
SK_24:
  s_barrier
  s_cmp_lg_u32 s3, 3
  s_cbranch_scc1 SK_26
  s_add_u32 s54, s18, 0
  buffer_load_dwordx2 v[48:49], v64, s[44:47], s54 offen sc0 sc1
  s_add_u32 s54, s18, 20480
  buffer_load_dwordx2 v[50:51], v64, s[44:47], s54 offen sc0 sc1
  s_add_u32 s54, s18, 40960
  buffer_load_dwordx2 v[52:53], v64, s[44:47], s54 offen sc0 sc1
  s_add_u32 s54, s18, 61440
  buffer_load_dwordx2 v[54:55], v64, s[44:47], s54 offen sc0 sc1
  s_add_u32 s54, s18, 81920
  buffer_load_dwordx2 v[56:57], v64, s[44:47], s54 offen sc0 sc1
  s_add_u32 s54, s18, 102400
  buffer_load_dwordx2 v[58:59], v64, s[44:47], s54 offen sc0 sc1
  s_add_u32 s54, s18, 122880
  buffer_load_dwordx2 v[60:61], v64, s[44:47], s54 offen sc0 sc1
  s_add_u32 s54, s18, 143360
  buffer_load_dwordx2 v[62:63], v64, s[44:47], s54 offen sc0 sc1
SK_26:
  v_mov_b32 v99, 0
  ds_read_b128 v[100:103], v99 offset:13552
  s_mov_b32 s61, 0
FW_27:
  s_waitcnt lgkmcnt(0)
  v_or_b32 v100, v100, v101
  v_or3_b32 v100, v100, v102, v103
  s_nop 0
  v_readfirstlane_b32 s57, v100
  s_cmp_eq_u32 s57, 0
  s_cbranch_scc1 FW_28
  ds_read_b128 v[100:103], v99 offset:13552
  s_add_u32 s61, s61, 1
  s_cmp_lt_u32 s61, 1048576
  s_cbranch_scc1 FW_27
  s_mov_b32 s52, 14
  s_branch L_timeout
FW_28:
  ds_read_b64_tr_b16 v[128:129], v120 offset:0
  ds_read_b64_tr_b16 v[130:131], v120 offset:512
  ds_read_b64_tr_b16 v[132:133], v120 offset:4096
  ds_read_b64_tr_b16 v[134:135], v120 offset:4608
  ds_read_b64_tr_b16 v[136:137], v120 offset:8192
  ds_read_b64_tr_b16 v[138:139], v120 offset:8704
  ds_read_b64_tr_b16 v[140:141], v120 offset:12288
  ds_read_b64_tr_b16 v[142:143], v120 offset:12800
  ds_read_b64_tr_b16 v[144:145], v120 offset:16384
  ds_read_b64_tr_b16 v[146:147], v120 offset:16896
  ds_read_b64_tr_b16 v[148:149], v120 offset:20480
  ds_read_b64_tr_b16 v[150:151], v120 offset:20992
  s_cmp_lt_u32 s30, 6
  s_cbranch_scc1 SK_29
  ds_read_b64_tr_b16 v[152:153], v120 offset:24576
  ds_read_b64_tr_b16 v[154:155], v120 offset:25088
  ds_read_b64_tr_b16 v[156:157], v120 offset:28672
  ds_read_b64_tr_b16 v[158:159], v120 offset:29184
  ds_read_b64_tr_b16 v[160:161], v120 offset:32768
  ds_read_b64_tr_b16 v[162:163], v120 offset:33280
  ds_read_b64_tr_b16 v[164:165], v120 offset:36864
  ds_read_b64_tr_b16 v[166:167], v120 offset:37376
  ds_read_b64_tr_b16 v[168:169], v120 offset:40960
  ds_read_b64_tr_b16 v[170:171], v120 offset:41472
  ds_read_b64_tr_b16 v[172:173], v120 offset:45056
  ds_read_b64_tr_b16 v[174:175], v120 offset:45568
SK_29:
L_s2_gemv:
  s_waitcnt lgkmcnt(0)
  s_barrier
  ds_read_b128 v[16:19], v8 offset:7424
  ds_read_b128 v[20:23], v8 offset:7488
  ds_read_b128 v[24:27], v8 offset:7552
  ds_read_b128 v[28:31], v8 offset:7616
  ds_read_b128 v[32:35], v8 offset:7680
  ds_read_b128 v[36:39], v8 offset:7744
  s_cmp_ge_u32 s30, 6
  s_cbranch_scc1 L_s2_two
  s_waitcnt lgkmcnt(5)
  v_mfma_f32_16x16x32_bf16 v[40:43], v[16:19], v[128:131], 0
  s_waitcnt lgkmcnt(4)
  v_mfma_f32_16x16x32_bf16 v[40:43], v[20:23], v[132:135], v[40:43]
  s_waitcnt lgkmcnt(3)
  v_mfma_f32_16x16x32_bf16 v[40:43], v[24:27], v[136:139], v[40:43]
  s_waitcnt lgkmcnt(2)
  v_mfma_f32_16x16x32_bf16 v[40:43], v[28:31], v[140:143], v[40:43]
  s_waitcnt lgkmcnt(1)
  v_mfma_f32_16x16x32_bf16 v[40:43], v[32:35], v[144:147], v[40:43]
  s_waitcnt lgkmcnt(0)
  v_mfma_f32_16x16x32_bf16 v[40:43], v[36:39], v[148:151], v[40:43]
  s_nop 7
  v_mov_b32 v41, s32
  s_mov_b64 exec, 0xffff
  s_cmp_eq_u32 s67, 0
  s_cbranch_scc1 YS_30
  buffer_store_dwordx2 v[40:41], v7, s[44:47], s69 offen offset:0
  s_branch YD_31
YS_30:
  buffer_store_dwordx2 v[40:41], v7, s[44:47], s69 offen offset:0 sc0 sc1
YD_31:
  s_mov_b64 exec, -1
  s_branch L_s2_done
L_s2_two:
  s_waitcnt lgkmcnt(5)
  v_mfma_f32_16x16x32_bf16 v[40:43], v[16:19], v[128:131], 0
  v_mfma_f32_16x16x32_bf16 v[44:47], v[16:19], v[152:155], 0
  s_waitcnt lgkmcnt(4)
  v_mfma_f32_16x16x32_bf16 v[40:43], v[20:23], v[132:135], v[40:43]
  v_mfma_f32_16x16x32_bf16 v[44:47], v[20:23], v[156:159], v[44:47]
  s_waitcnt lgkmcnt(3)
  v_mfma_f32_16x16x32_bf16 v[40:43], v[24:27], v[136:139], v[40:43]
  v_mfma_f32_16x16x32_bf16 v[44:47], v[24:27], v[160:163], v[44:47]
  s_waitcnt lgkmcnt(2)
  v_mfma_f32_16x16x32_bf16 v[40:43], v[28:31], v[140:143], v[40:43]
  v_mfma_f32_16x16x32_bf16 v[44:47], v[28:31], v[164:167], v[44:47]
  s_waitcnt lgkmcnt(1)
  v_mfma_f32_16x16x32_bf16 v[40:43], v[32:35], v[144:147], v[40:43]
  v_mfma_f32_16x16x32_bf16 v[44:47], v[32:35], v[168:171], v[44:47]
  s_waitcnt lgkmcnt(0)
  v_mfma_f32_16x16x32_bf16 v[40:43], v[36:39], v[148:151], v[40:43]
  v_mfma_f32_16x16x32_bf16 v[44:47], v[36:39], v[172:175], v[44:47]
  s_nop 7
  v_mov_b32 v41, s32
  s_mov_b64 exec, 0xffff
  s_cmp_eq_u32 s67, 0
  s_cbranch_scc1 YS_32
  buffer_store_dwordx2 v[40:41], v7, s[44:47], s69 offen offset:0
  s_branch YD_33
YS_32:
  buffer_store_dwordx2 v[40:41], v7, s[44:47], s69 offen offset:0 sc0 sc1
YD_33:
  s_mov_b64 exec, -1
  v_mov_b32 v45, s32
  s_mov_b64 exec, 0xffff
  s_cmp_eq_u32 s67, 0
  s_cbranch_scc1 YS_34
  buffer_store_dwordx2 v[44:45], v7, s[44:47], s69 offen offset:1024
  s_branch YD_35
YS_34:
  buffer_store_dwordx2 v[44:45], v7, s[44:47], s69 offen offset:1024 sc0 sc1
YD_35:
  s_mov_b64 exec, -1
L_s2_done:
  s_cmp_eq_u32 s3, 1
  s_cbranch_scc1 L_s4
  s_cmp_eq_u32 s3, 2
  s_cbranch_scc1 L_s5
  s_cmp_lg_u32 s3, 3
  s_cbranch_scc1 L_fin
  s_mov_b32 s61, 0
PS_36:
  s_waitcnt vmcnt(0)
  v_xor_b32 v94, s32, v49
  v_bitop3_b32 v94, v51, v94, s32 bitop3:0xde
  v_bitop3_b32 v94, v53, v94, s32 bitop3:0xde
  v_bitop3_b32 v94, v55, v94, s32 bitop3:0xde
  v_bitop3_b32 v94, v57, v94, s32 bitop3:0xde
  v_bitop3_b32 v94, v59, v94, s32 bitop3:0xde
  v_bitop3_b32 v94, v61, v94, s32 bitop3:0xde
  v_bitop3_b32 v94, v63, v94, s32 bitop3:0xde
  v_cmp_ne_u32 vcc, 0, v94
  s_nop 1
  s_cbranch_vccz PD_37
  s_add_u32 s61, s61, 1
  s_cmp_ge_u32 s61, 65536
  s_cbranch_scc1 PT_38
  v_cmp_ne_u32 vcc, s32, v49
  s_nop 1
  s_cbranch_vccz PK_39
  s_mov_b64 exec, vcc
  s_add_u32 s54, s18, 0
  buffer_load_dwordx2 v[48:49], v64, s[44:47], s54 offen sc0 sc1
  s_mov_b64 exec, -1
PK_39:
  v_cmp_ne_u32 vcc, s32, v51
  s_nop 1
  s_cbranch_vccz PK_40
  s_mov_b64 exec, vcc
  s_add_u32 s54, s18, 20480
  buffer_load_dwordx2 v[50:51], v64, s[44:47], s54 offen sc0 sc1
  s_mov_b64 exec, -1
PK_40:
  v_cmp_ne_u32 vcc, s32, v53
  s_nop 1
  s_cbranch_vccz PK_41
  s_mov_b64 exec, vcc
  s_add_u32 s54, s18, 40960
  buffer_load_dwordx2 v[52:53], v64, s[44:47], s54 offen sc0 sc1
  s_mov_b64 exec, -1
PK_41:
  v_cmp_ne_u32 vcc, s32, v55
  s_nop 1
  s_cbranch_vccz PK_42
  s_mov_b64 exec, vcc
  s_add_u32 s54, s18, 61440
  buffer_load_dwordx2 v[54:55], v64, s[44:47], s54 offen sc0 sc1
  s_mov_b64 exec, -1
PK_42:
  v_cmp_ne_u32 vcc, s32, v57
  s_nop 1
  s_cbranch_vccz PK_43
  s_mov_b64 exec, vcc
  s_add_u32 s54, s18, 81920
  buffer_load_dwordx2 v[56:57], v64, s[44:47], s54 offen sc0 sc1
  s_mov_b64 exec, -1
PK_43:
  v_cmp_ne_u32 vcc, s32, v59
  s_nop 1
  s_cbranch_vccz PK_44
  s_mov_b64 exec, vcc
  s_add_u32 s54, s18, 102400
  buffer_load_dwordx2 v[58:59], v64, s[44:47], s54 offen sc0 sc1
  s_mov_b64 exec, -1
PK_44:
  v_cmp_ne_u32 vcc, s32, v61
  s_nop 1
  s_cbranch_vccz PK_45
  s_mov_b64 exec, vcc
  s_add_u32 s54, s18, 122880
  buffer_load_dwordx2 v[60:61], v64, s[44:47], s54 offen sc0 sc1
  s_mov_b64 exec, -1
PK_45:
  v_cmp_ne_u32 vcc, s32, v63
  s_nop 1
  s_cbranch_vccz PK_46
  s_mov_b64 exec, vcc
  s_add_u32 s54, s18, 143360
  buffer_load_dwordx2 v[62:63], v64, s[44:47], s54 offen sc0 sc1
  s_mov_b64 exec, -1
PK_46:
  s_branch PS_36
PT_38:
  s_mov_b32 s52, 3
  s_branch L_timeout
PD_37:
  v_add_f32 v48, v48, v50
  v_add_f32 v52, v52, v54
  v_add_f32 v56, v56, v58
  v_add_f32 v60, v60, v62
  v_add_f32 v48, v48, v52
  v_add_f32 v56, v56, v60
  v_add_f32 v48, v48, v56
  v_mov_b32 v82, v48
  s_nop 1
  v_permlane16_swap_b32 v48, v82
  v_add_f32 v48, v48, v82
  v_mov_b32 v82, v48
  s_nop 1
  v_permlane32_swap_b32 v48, v82
  v_add_f32 v48, v48, v82
  v_cvt_pk_bf16_f32 v48, v48, v48
  v_and_b32 v48, 0xffff0000, v48
  v_lshlrev_b32 v83, 16, v6
  v_add_f32 v48, v48, v83
  v_mov_b32 v51, s32
  s_nop 0
  v_mov_b32_dpp v49, v48 quad_perm:[1,1,3,3] row_mask:0xf bank_mask:0xf
  v_mov_b32_dpp v52, v48 quad_perm:[0,0,2,2] row_mask:0xf bank_mask:0xf
  v_cvt_pk_bf16_f32 v50, v52, v49
  buffer_store_dwordx2 v[50:51], v65, s[48:51], s19 offen sc0 sc1
  s_cmp_eq_u32 s67, 0
  s_cbranch_scc1 BR_47
  s_lshl_b32 s54, s15, 3
  s_lshl_b32 s55, s30, 9
  s_add_u32 s54, s54, s55
  s_add_u32 s54, s54, 36864
  v_mov_b32 v82, 0
  s_mov_b64 exec, 1
  buffer_store_dwordx2 v[50:51], v82, s[48:51], s54 offen
  s_mov_b64 exec, -1
BR_47:
  s_branch L_fin
L_s4:
  v_lshlrev_b32 v9, 3, v1
  s_and_b32 s52, s30, 7
  s_lshl_b32 s52, s52, 12
  s_add_u32 s52, s52, 1900544
  s_lshr_b32 s56, s96, 3
  s_lshl_b32 s56, s56, 3
  s_add_u32 s56, s56, s30
  s_lshl_b32 s56, s56, 3
  s_and_b32 s53, s96, 7
  s_add_u32 s56, s56, s53
  s_lshl_b32 s56, s56, 5
  s_add_u32 s56, s56, 1933312
  v_mov_b32 v37, 0x3f80
  v_mov_b32 v38, 1.0
  v_mov_b32 v39, 0x3acccccd
  v_lshlrev_b32 v10, 2, v1
  v_lshrrev_b32 v11, 1, v7
  v_and_b32 v11, 0x38, v11
  v_lshl_add_u32 v11, v8, 9, v11
  v_mov_b32 v13, s32
  s_mov_b32 s55, s52
  s_lshr_b32 s52, s96, 3
  s_lshl_b32 s52, s52, 3
  s_add_u32 s52, s52, s30
  s_lshl_b32 s52, s52, 3
  s_and_b32 s53, s96, 7
  s_add_u32 s52, s52, s53
  s_lshl_b32 s52, s52, 4
  s_add_u32 s36, s16, s52
  s_addc_u32 s37, s17, 0
  s_and_b32 s37, s37, 0xffff
  s_sub_u32 s38, 1966080, s52
  s_mov_b32 s39, 0x20000
  s_add_u32 s40, s18, s52
  s_addc_u32 s41, s19, 0
  s_and_b32 s41, s41, 0xffff
  s_sub_u32 s42, 1966080, s52
  s_mov_b32 s43, 0x20000
  s_mov_b32 s52, s55
  v_mul_u32_u24 v26, 3072, v1
  s_mov_b32 s53, 0
  s_mov_b32 m0, 13824
  s_nop 0
  buffer_load_dwordx4 v26, s[36:39], s53 offen lds
  s_mov_b32 m0, 24064
  s_nop 0
  buffer_load_dwordx4 v26, s[40:43], s53 offen lds
  s_mov_b32 s53, 196608
  s_mov_b32 m0, 14848
  s_nop 0
  buffer_load_dwordx4 v26, s[36:39], s53 offen lds
  s_mov_b32 m0, 25088
  s_nop 0
  buffer_load_dwordx4 v26, s[40:43], s53 offen lds
  s_mov_b32 s53, 393216
  s_mov_b32 m0, 15872
  s_nop 0
  buffer_load_dwordx4 v26, s[36:39], s53 offen lds
  s_mov_b32 m0, 26112
  s_nop 0
  buffer_load_dwordx4 v26, s[40:43], s53 offen lds
  s_mov_b32 s53, 589824
  s_mov_b32 m0, 16896
  s_nop 0
  buffer_load_dwordx4 v26, s[36:39], s53 offen lds
  s_mov_b32 m0, 27136
  s_nop 0
  buffer_load_dwordx4 v26, s[40:43], s53 offen lds
  s_mov_b32 s53, 786432
  s_mov_b32 m0, 17920
  s_nop 0
  buffer_load_dwordx4 v26, s[36:39], s53 offen lds
  s_mov_b32 m0, 28160
  s_nop 0
  buffer_load_dwordx4 v26, s[40:43], s53 offen lds
  s_mov_b32 s53, 983040
  s_mov_b32 m0, 18944
  s_nop 0
  buffer_load_dwordx4 v26, s[36:39], s53 offen lds
  s_mov_b32 m0, 29184
  s_nop 0
  buffer_load_dwordx4 v26, s[40:43], s53 offen lds
  s_mov_b32 s53, 1179648
  s_mov_b32 m0, 19968
  s_nop 0
  buffer_load_dwordx4 v26, s[36:39], s53 offen lds
  s_mov_b32 m0, 30208
  s_nop 0
  buffer_load_dwordx4 v26, s[40:43], s53 offen lds
  s_mov_b32 s53, 1376256
  s_mov_b32 m0, 20992
  s_nop 0
  buffer_load_dwordx4 v26, s[36:39], s53 offen lds
  s_mov_b32 m0, 31232
  s_nop 0
  buffer_load_dwordx4 v26, s[40:43], s53 offen lds
  s_mov_b32 s53, 1572864
  s_mov_b32 m0, 22016
  s_nop 0
  buffer_load_dwordx4 v26, s[36:39], s53 offen lds
  s_mov_b32 m0, 32256
  s_nop 0
  buffer_load_dwordx4 v26, s[40:43], s53 offen lds
  s_mov_b32 s53, 1769472
  s_mov_b32 m0, 23040
  s_nop 0
  buffer_load_dwordx4 v26, s[36:39], s53 offen lds
  s_mov_b32 m0, 33280
  s_nop 0
  buffer_load_dwordx4 v26, s[40:43], s53 offen lds
  s_waitcnt vmcnt(0)
  ds_read_b64_tr_b16 v[176:177], v121 offset:0
  ds_read_b64_tr_b16 v[178:179], v121 offset:64
  ds_read_b64_tr_b16 v[180:181], v121 offset:512
  ds_read_b64_tr_b16 v[182:183], v121 offset:576
  ds_read_b64_tr_b16 v[184:185], v121 offset:1024
  ds_read_b64_tr_b16 v[186:187], v121 offset:1088
  ds_read_b64_tr_b16 v[188:189], v121 offset:1536
  ds_read_b64_tr_b16 v[190:191], v121 offset:1600
  ds_read_b64_tr_b16 v[192:193], v121 offset:2048
  ds_read_b64_tr_b16 v[194:195], v121 offset:2112
  ds_read_b64_tr_b16 v[196:197], v121 offset:2560
  ds_read_b64_tr_b16 v[198:199], v121 offset:2624
  ds_read_b64_tr_b16 v[200:201], v121 offset:3072
  ds_read_b64_tr_b16 v[202:203], v121 offset:3136
  ds_read_b64_tr_b16 v[204:205], v121 offset:3584
  ds_read_b64_tr_b16 v[206:207], v121 offset:3648
  ds_read_b64_tr_b16 v[208:209], v121 offset:4096
  ds_read_b64_tr_b16 v[210:211], v121 offset:4160
  ds_read_b64_tr_b16 v[212:213], v121 offset:4608
  ds_read_b64_tr_b16 v[214:215], v121 offset:4672
  ds_read_b64_tr_b16 v[216:217], v121 offset:5120
  ds_read_b64_tr_b16 v[218:219], v121 offset:5184
  ds_read_b64_tr_b16 v[220:221], v121 offset:5632
  ds_read_b64_tr_b16 v[222:223], v121 offset:5696
  ds_read_b64_tr_b16 v[224:225], v121 offset:6144
  ds_read_b64_tr_b16 v[226:227], v121 offset:6208
  ds_read_b64_tr_b16 v[228:229], v121 offset:6656
  ds_read_b64_tr_b16 v[230:231], v121 offset:6720
  ds_read_b64_tr_b16 v[232:233], v121 offset:7168
  ds_read_b64_tr_b16 v[234:235], v121 offset:7232
  ds_read_b64_tr_b16 v[236:237], v121 offset:7680
  ds_read_b64_tr_b16 v[238:239], v121 offset:7744
  ds_read_b64_tr_b16 v[240:241], v121 offset:8192
  ds_read_b64_tr_b16 v[242:243], v121 offset:8256
  ds_read_b64_tr_b16 v[244:245], v121 offset:8704
  ds_read_b64_tr_b16 v[246:247], v121 offset:8768
  ds_read_b64_tr_b16 v[248:249], v121 offset:9216
  ds_read_b64_tr_b16 v[250:251], v121 offset:9280
  ds_read_b64_tr_b16 v[252:253], v121 offset:9728
  ds_read_b64_tr_b16 v[254:255], v121 offset:9792
  s_waitcnt lgkmcnt(0)
  s_cmp_eq_u32 s67, 0
  s_cbranch_scc1 BS_51
  s_lshl_b32 s54, s30, 9
  s_add_u32 s54, s54, 36864
  v_lshlrev_b32 v26, 7, v1
  v_add_u32 v26, 120, v26
  s_mov_b64 exec, 1
  buffer_store_dwordx2 v[28:29], v26, s[44:47], s54 offen
  s_mov_b64 exec, -1
  s_cmp_ge_u32 s30, 6
  s_cselect_b32 s55, 7, 3
  v_min_u32 v26, s55, v1
  v_lshlrev_b32 v26, 3, v26
  s_mov_b32 s61, 0
POLL_52:
  buffer_load_dwordx2 v[28:29], v26, s[44:47], s54 offen sc0 sc1
  s_waitcnt vmcnt(0)
  v_xor_b32 v28, s32, v29
  v_cmp_ne_u32 vcc, 0, v28
  s_nop 1
  s_cbranch_vccz PD_53
  s_add_u32 s61, s61, 1
  s_cmp_lt_u32 s61, 65536
  s_cbranch_scc1 POLL_52
  s_mov_b32 s52, 10
  s_branch L_timeout
PD_53:
BS_51:
  s_mov_b32 s61, 0
POLL_54:
  buffer_load_dwordx2 v[16:17], v9, s[44:47], s52 offen offset:0 sc0 sc1
  buffer_load_dwordx2 v[18:19], v9, s[44:47], s52 offen offset:512 sc0 sc1
  buffer_load_dwordx2 v[20:21], v9, s[44:47], s52 offen offset:1024 sc0 sc1
  buffer_load_dwordx2 v[22:23], v9, s[44:47], s52 offen offset:1536 sc0 sc1
  buffer_load_dwordx2 v[24:25], v9, s[44:47], s52 offen offset:2048 sc0 sc1
  s_waitcnt vmcnt(0)
  v_xor_b32 v36, s32, v17
  v_bitop3_b32 v36, v19, v36, s32 bitop3:0xde
  v_bitop3_b32 v36, v21, v36, s32 bitop3:0xde
  v_bitop3_b32 v36, v23, v36, s32 bitop3:0xde
  v_bitop3_b32 v36, v25, v36, s32 bitop3:0xde
  v_cmp_ne_u32 vcc, 0, v36
  s_nop 1
  s_cbranch_vccz PD_55
  s_add_u32 s61, s61, 1
  s_cmp_lt_u32 s61, 65536
  s_cbranch_scc1 POLL_54
  s_mov_b32 s52, 4
  s_branch L_timeout
PD_55:
  v_dot2_f32_bf16 v26, v16, s64, 0
  v_dot2_f32_bf16 v27, v16, v16, 0
  v_dot2_f32_bf16 v26, v18, s64, v26
  v_dot2_f32_bf16 v27, v18, v18, v27
  v_dot2_f32_bf16 v26, v20, s64, v26
  v_dot2_f32_bf16 v27, v20, v20, v27
  v_dot2_f32_bf16 v26, v22, s64, v26
  v_dot2_f32_bf16 v27, v22, v22, v27
  v_dot2_f32_bf16 v26, v24, s64, v26
  v_dot2_f32_bf16 v27, v24, v24, v27
  s_nop 1
  s_nop 0
  v_add_f32_dpp v26, v26, v26 quad_perm:[1,0,3,2] row_mask:0xf bank_mask:0xf
  v_add_f32_dpp v27, v27, v27 quad_perm:[1,0,3,2] row_mask:0xf bank_mask:0xf
  s_nop 0
  v_add_f32_dpp v26, v26, v26 quad_perm:[2,3,0,1] row_mask:0xf bank_mask:0xf
  v_add_f32_dpp v27, v27, v27 quad_perm:[2,3,0,1] row_mask:0xf bank_mask:0xf
  s_nop 0
  v_add_f32_dpp v26, v26, v26 row_half_mirror row_mask:0xf bank_mask:0xf
  v_add_f32_dpp v27, v27, v27 row_half_mirror row_mask:0xf bank_mask:0xf
  s_nop 0
  v_add_f32_dpp v26, v26, v26 row_ror:8 row_mask:0xf bank_mask:0xf
  v_add_f32_dpp v27, v27, v27 row_ror:8 row_mask:0xf bank_mask:0xf
  s_nop 0
  v_add_f32_dpp v26, v26, v26 row_bcast:15 row_mask:0xa bank_mask:0xf
  v_add_f32_dpp v27, v27, v27 row_bcast:15 row_mask:0xa bank_mask:0xf
  s_nop 0
  v_add_f32_dpp v26, v26, v26 row_bcast:31 row_mask:0xc bank_mask:0xf
  v_add_f32_dpp v27, v27, v27 row_bcast:31 row_mask:0xc bank_mask:0xf
  v_mul_f32 v26, v26, v39
  v_mul_f32 v27, v27, v39
  v_fma_f32 v27, -v26, v26, v27
  v_cvt_pk_bf16_f32 v26, -v26, -v26
  v_max_f32 v27, 0, v27
  v_cvt_pk_bf16_f32 v27, v27, v27
  v_and_b32 v27, 0xffff0000, v27
  v_add_f32 v27, 0x3727c5ac, v27
  v_and_b32 v26, 0xffff0000, v26
  v_cvt_pk_bf16_f32 v27, v27, v27
  v_and_b32 v27, 0xffff0000, v27
  v_sqrt_f32 v27, v27
  v_readlane_b32 s53, v26, 63
  v_cvt_pk_bf16_f32 v27, v27, v27
  v_and_b32 v27, 0xffff0000, v27
  v_rcp_f32 v27, v27
  s_nop 0
  v_readlane_b32 s66, v27, 63
  v_dot2_f32_bf16 v28, v16, v37, s53
  v_dot2_f32_bf16 v29, v16, v38, s53
  v_dot2_f32_bf16 v32, v18, v37, s53
  v_dot2_f32_bf16 v33, v18, v38, s53
  s_nop 0
  v_cvt_pk_bf16_f32 v30, v28, v29
  v_lshlrev_b32 v28, 16, v30
  v_and_b32 v29, s35, v30
  v_pk_mul_f32 v[28:29], v[28:29], s[66:67] op_sel_hi:[1,0]
  v_cvt_pk_bf16_f32 v30, v28, v29
  ds_write_b32 v10, v30 offset:8192
  ds_read_b128 v[48:51], v8 offset:8192
  ds_read_b128 v[52:55], v8 offset:8256
  ds_read_b128 v[56:59], v8 offset:8320
  ds_read_b128 v[60:63], v8 offset:8384
  v_dot2_f32_bf16 v28, v20, v37, s53
  v_dot2_f32_bf16 v29, v20, v38, s53
  v_cvt_pk_bf16_f32 v34, v32, v33
  v_lshlrev_b32 v32, 16, v34
  v_and_b32 v33, s35, v34
  v_pk_mul_f32 v[32:33], v[32:33], s[66:67] op_sel_hi:[1,0]
  v_cvt_pk_bf16_f32 v34, v32, v33
  ds_write_b32 v10, v34 offset:8448
  ds_read_b128 v[64:67], v8 offset:8448
  ds_read_b128 v[68:71], v8 offset:8512
  ds_read_b128 v[72:75], v8 offset:8576
  ds_read_b128 v[76:79], v8 offset:8640
  v_dot2_f32_bf16 v32, v22, v37, s53
  v_dot2_f32_bf16 v33, v22, v38, s53
  s_nop 0
  v_cvt_pk_bf16_f32 v30, v28, v29
  v_lshlrev_b32 v28, 16, v30
  v_and_b32 v29, s35, v30
  v_pk_mul_f32 v[28:29], v[28:29], s[66:67] op_sel_hi:[1,0]
  v_cvt_pk_bf16_f32 v30, v28, v29
  ds_write_b32 v10, v30 offset:8704
  ds_read_b128 v[80:83], v8 offset:8704
  ds_read_b128 v[84:87], v8 offset:8768
  ds_read_b128 v[88:91], v8 offset:8832
  ds_read_b128 v[92:95], v8 offset:8896
  s_waitcnt lgkmcnt(13)
  v_mfma_f32_16x16x32_bf16 v[40:43], v[48:51], v[176:179], 0
  s_waitcnt lgkmcnt(12)
  v_mfma_f32_16x16x32_bf16 v[44:47], v[52:55], v[180:183], 0
  s_waitcnt lgkmcnt(11)
  v_mfma_f32_16x16x32_bf16 v[40:43], v[56:59], v[184:187], v[40:43]
  s_waitcnt lgkmcnt(10)
  v_mfma_f32_16x16x32_bf16 v[44:47], v[60:63], v[188:191], v[44:47]
  v_dot2_f32_bf16 v28, v24, v37, s53
  v_dot2_f32_bf16 v29, v24, v38, s53
  v_cvt_pk_bf16_f32 v34, v32, v33
  v_lshlrev_b32 v32, 16, v34
  v_and_b32 v33, s35, v34
  v_pk_mul_f32 v[32:33], v[32:33], s[66:67] op_sel_hi:[1,0]
  v_cvt_pk_bf16_f32 v34, v32, v33
  ds_write_b32 v10, v34 offset:8960
  ds_read_b128 v[96:99], v8 offset:8960
  ds_read_b128 v[100:103], v8 offset:9024
  ds_read_b128 v[104:107], v8 offset:9088
  ds_read_b128 v[108:111], v8 offset:9152
  s_waitcnt lgkmcnt(13)
  v_mfma_f32_16x16x32_bf16 v[40:43], v[64:67], v[192:195], v[40:43]
  s_waitcnt lgkmcnt(12)
  v_mfma_f32_16x16x32_bf16 v[44:47], v[68:71], v[196:199], v[44:47]
  s_waitcnt lgkmcnt(11)
  v_mfma_f32_16x16x32_bf16 v[40:43], v[72:75], v[200:203], v[40:43]
  s_waitcnt lgkmcnt(10)
  v_mfma_f32_16x16x32_bf16 v[44:47], v[76:79], v[204:207], v[44:47]
  s_nop 0
  v_cvt_pk_bf16_f32 v30, v28, v29
  v_lshlrev_b32 v28, 16, v30
  v_and_b32 v29, s35, v30
  v_pk_mul_f32 v[28:29], v[28:29], s[66:67] op_sel_hi:[1,0]
  v_cvt_pk_bf16_f32 v30, v28, v29
  ds_write_b32 v10, v30 offset:9216
  ds_read_b128 v[112:115], v8 offset:9216
  ds_read_b128 v[116:119], v8 offset:9280
  ds_read_b128 v[120:123], v8 offset:9344
  ds_read_b128 v[124:127], v8 offset:9408
  s_waitcnt lgkmcnt(13)
  v_mfma_f32_16x16x32_bf16 v[40:43], v[80:83], v[208:211], v[40:43]
  s_waitcnt lgkmcnt(12)
  v_mfma_f32_16x16x32_bf16 v[44:47], v[84:87], v[212:215], v[44:47]
  s_waitcnt lgkmcnt(11)
  v_mfma_f32_16x16x32_bf16 v[40:43], v[88:91], v[216:219], v[40:43]
  s_waitcnt lgkmcnt(10)
  v_mfma_f32_16x16x32_bf16 v[44:47], v[92:95], v[220:223], v[44:47]
  s_waitcnt lgkmcnt(8)
  v_mfma_f32_16x16x32_bf16 v[40:43], v[96:99], v[224:227], v[40:43]
  s_waitcnt lgkmcnt(7)
  v_mfma_f32_16x16x32_bf16 v[44:47], v[100:103], v[228:231], v[44:47]
  s_waitcnt lgkmcnt(6)
  v_mfma_f32_16x16x32_bf16 v[40:43], v[104:107], v[232:235], v[40:43]
  s_waitcnt lgkmcnt(5)
  v_mfma_f32_16x16x32_bf16 v[44:47], v[108:111], v[236:239], v[44:47]
  s_waitcnt lgkmcnt(3)
  v_mfma_f32_16x16x32_bf16 v[40:43], v[112:115], v[240:243], v[40:43]
  s_waitcnt lgkmcnt(2)
  v_mfma_f32_16x16x32_bf16 v[44:47], v[116:119], v[244:247], v[44:47]
  s_waitcnt lgkmcnt(1)
  v_mfma_f32_16x16x32_bf16 v[40:43], v[120:123], v[248:251], v[40:43]
  s_waitcnt lgkmcnt(0)
  v_mfma_f32_16x16x32_bf16 v[44:47], v[124:127], v[252:255], v[44:47]
  s_nop 7
  v_add_f32 v16, v40, v44
  v_cvt_pk_bf16_f32 v16, v16, v16
  v_and_b32 v16, 0xffff0000, v16
  v_mul_f32 v17, s65, v16
  v_exp_f32 v17, v17
  v_mov_b32_dpp v18, v16 row_ror:8 row_mask:0xf bank_mask:0xf
  v_add_f32 v17, 1.0, v17
  v_rcp_f32 v17, v17
  s_nop 0
  v_cvt_pk_bf16_f32 v17, v17, v17
  v_and_b32 v17, 0xffff0000, v17
  v_mul_f32 v17, v17, v18
  s_nop 1
  v_mov_b32_dpp v18, v17 quad_perm:[1,1,3,3] row_mask:0xf bank_mask:0xf
  v_cvt_pk_bf16_f32 v12, v17, v18
  s_mov_b32 exec_lo, 0x00550055
  s_mov_b32 exec_hi, 0x00550055
  buffer_store_dwordx2 v[12:13], v11, s[48:51], s56 offen sc0 sc1
  s_mov_b64 exec, -1
  s_cmp_eq_u32 s67, 0
  s_cbranch_scc1 BR_56
  s_lshl_b32 s54, s96, 3
  s_add_u32 s55, s54, 32
  s_cmp_ge_u32 s96, 12
  s_cselect_b32 s54, s55, s54
  s_add_u32 s54, s54, 128
  s_lshl_b32 s55, s30, 9
  s_add_u32 s54, s54, s55
  s_add_u32 s54, s54, 36864
  v_mov_b32 v14, 0
  s_mov_b64 exec, 1
  buffer_store_dwordx2 v[12:13], v14, s[48:51], s54 offen
  s_mov_b64 exec, -1
BR_56:
  s_branch L_fin
L_s5:
  s_cmp_lt_u32 s96, 28
  s_cbranch_scc1 T5_57
  s_lshl_b32 s56, s30, 1
  s_and_b32 s53, s96, 1
  s_add_u32 s56, s56, s53
  s_add_u32 s56, s56, 32
  s_branch T5_58
T5_57:
  s_lshl_b32 s56, s30, 2
  s_and_b32 s53, s96, 3
  s_add_u32 s56, s56, s53
T5_58:
  s_lshl_b32 s52, s56, 5
  s_mul_i32 s53, s31, 491520
  s_add_u32 s52, s52, s53
  s_add_u32 s36, s20, s52
  s_addc_u32 s37, s21, 0
  s_and_b32 s37, s37, 0xffff
  s_sub_u32 s38, 1966080, s52
  s_mov_b32 s39, 0x20000
  v_lshrrev_b32 v9, 1, v1
  v_mul_u32_u24 v9, 1280, v9
  v_and_b32 v10, 1, v1
  v_lshl_add_u32 v9, v10, 4, v9
  s_mul_i32 s52, s31, 12288
  s_add_u32 s52, s52, 13824
  s_add_u32 m0, s52, 0
  s_mov_b32 s53, 0
  buffer_load_dwordx4 v9, s[36:39], s53 offen lds
  s_add_u32 m0, s52, 1024
  s_mov_b32 s53, 40960
  buffer_load_dwordx4 v9, s[36:39], s53 offen lds
  s_add_u32 m0, s52, 2048
  s_mov_b32 s53, 81920
  buffer_load_dwordx4 v9, s[36:39], s53 offen lds
  s_add_u32 m0, s52, 3072
  s_mov_b32 s53, 122880
  buffer_load_dwordx4 v9, s[36:39], s53 offen lds
  s_add_u32 m0, s52, 4096
  s_mov_b32 s53, 163840
  buffer_load_dwordx4 v9, s[36:39], s53 offen lds
  s_add_u32 m0, s52, 5120
  s_mov_b32 s53, 204800
  buffer_load_dwordx4 v9, s[36:39], s53 offen lds
  s_add_u32 m0, s52, 6144
  s_mov_b32 s53, 245760
  buffer_load_dwordx4 v9, s[36:39], s53 offen lds
  s_add_u32 m0, s52, 7168
  s_mov_b32 s53, 286720
  buffer_load_dwordx4 v9, s[36:39], s53 offen lds
  s_add_u32 m0, s52, 8192
  s_mov_b32 s53, 327680
  buffer_load_dwordx4 v9, s[36:39], s53 offen lds
  s_add_u32 m0, s52, 9216
  s_mov_b32 s53, 368640
  buffer_load_dwordx4 v9, s[36:39], s53 offen lds
  s_add_u32 m0, s52, 10240
  s_mov_b32 s53, 409600
  buffer_load_dwordx4 v9, s[36:39], s53 offen lds
  s_add_u32 m0, s52, 11264
  s_mov_b32 s53, 450560
  buffer_load_dwordx4 v9, s[36:39], s53 offen lds
  s_waitcnt vmcnt(0)
  ds_read_b64_tr_b16 v[176:177], v122 offset:0
  ds_read_b64_tr_b16 v[178:179], v122 offset:128
  ds_read_b64_tr_b16 v[180:181], v122 offset:1024
  ds_read_b64_tr_b16 v[182:183], v122 offset:1152
  ds_read_b64_tr_b16 v[184:185], v122 offset:2048
  ds_read_b64_tr_b16 v[186:187], v122 offset:2176
  ds_read_b64_tr_b16 v[188:189], v122 offset:3072
  ds_read_b64_tr_b16 v[190:191], v122 offset:3200
  ds_read_b64_tr_b16 v[192:193], v122 offset:4096
  ds_read_b64_tr_b16 v[194:195], v122 offset:4224
  ds_read_b64_tr_b16 v[196:197], v122 offset:5120
  ds_read_b64_tr_b16 v[198:199], v122 offset:5248
  ds_read_b64_tr_b16 v[200:201], v122 offset:6144
  ds_read_b64_tr_b16 v[202:203], v122 offset:6272
  ds_read_b64_tr_b16 v[204:205], v122 offset:7168
  ds_read_b64_tr_b16 v[206:207], v122 offset:7296
  ds_read_b64_tr_b16 v[208:209], v122 offset:8192
  ds_read_b64_tr_b16 v[210:211], v122 offset:8320
  ds_read_b64_tr_b16 v[212:213], v122 offset:9216
  ds_read_b64_tr_b16 v[214:215], v122 offset:9344
  ds_read_b64_tr_b16 v[216:217], v122 offset:10240
  ds_read_b64_tr_b16 v[218:219], v122 offset:10368
  ds_read_b64_tr_b16 v[220:221], v122 offset:11264
  ds_read_b64_tr_b16 v[222:223], v122 offset:11392
  s_waitcnt lgkmcnt(0)
  s_mov_b32 s36, s22
  s_mov_b32 s37, s23
  s_and_b32 s37, s37, 0xffff
  s_mov_b32 s38, 1280
  s_mov_b32 s39, 0x20000
  v_lshlrev_b32 v9, 3, v1
  s_mul_i32 s52, s31, 1536
  s_add_u32 s52, s52, 1933312
  s_and_b32 s53, s30, 3
  s_lshl_b32 s53, s53, 13
  s_add_u32 s52, s52, s53
  s_mul_i32 s53, s31, 768
  s_add_u32 s53, s53, 9728
  v_lshlrev_b32 v10, 2, v1
  v_add_u32 v10, s53, v10
  v_add_u32 v11, s53, v8
  v_lshrrev_b32 v12, 1, v7
  s_lshl_b32 s53, s31, 6
  v_add_u32 v13, s53, v12
  s_cmp_lg_u32 s31, 0
  s_cbranch_scc1 SK_59
  s_lshl_b32 s53, s56, 6
  s_add_u32 s53, s53, 1900544
  s_lshl_b32 s55, s30, 12
  s_add_u32 s53, s53, s55
  v_and_b32 v37, 0x38, v12
  s_cmp_eq_u32 s67, 0
  s_cbranch_scc1 BS_60
  s_lshl_b32 s54, s30, 9
  s_add_u32 s54, s54, 36864
  v_lshlrev_b32 v26, 7, v1
  v_add_u32 v26, 120, v26
  s_mov_b64 exec, 1
  buffer_store_dwordx2 v[28:29], v26, s[44:47], s54 offen
  s_mov_b64 exec, -1
  s_cmp_ge_u32 s30, 6
  s_cselect_b32 s55, 7, 3
  v_min_u32 v26, s55, v1
  v_lshlrev_b32 v26, 3, v26
  s_mov_b32 s61, 0
POLL_61:
  buffer_load_dwordx2 v[28:29], v26, s[44:47], s54 offen sc0 sc1
  s_waitcnt vmcnt(0)
  v_xor_b32 v28, s32, v29
  v_cmp_ne_u32 vcc, 0, v28
  s_nop 1
  s_cbranch_vccz PD_62
  s_add_u32 s61, s61, 1
  s_cmp_lt_u32 s61, 65536
  s_cbranch_scc1 POLL_61
  s_mov_b32 s52, 10
  s_branch L_timeout
PD_62:
BS_60:
  s_mov_b32 s61, 0
POLL_63:
  buffer_load_dwordx2 v[14:15], v37, s[44:47], s53 offen sc0 sc1
  s_waitcnt vmcnt(0)
  v_xor_b32 v36, s32, v15
  v_cmp_ne_u32 vcc, 0, v36
  s_nop 1
  s_cbranch_vccz PD_64
  s_add_u32 s61, s61, 1
  s_cmp_lt_u32 s61, 65536
  s_cbranch_scc1 POLL_63
  s_mov_b32 s52, 9
  s_branch L_timeout
PD_64:
  v_and_b32 v37, 1, v1
  v_cmp_eq_u32 vcc, 0, v37
  v_lshlrev_b32 v15, 16, v14
  v_and_b32 v14, s35, v14
  v_cndmask_b32 v14, v14, v15, vcc
SK_59:
  s_lshl_b32 s56, s56, 5
  s_cmp_eq_u32 s67, 0
  s_cbranch_scc1 BS_65
  s_lshl_b32 s54, s30, 9
  s_add_u32 s54, s54, 36992
  v_lshlrev_b32 v26, 7, v1
  v_add_u32 v26, 120, v26
  s_mov_b64 exec, 3
  buffer_store_dwordx2 v[28:29], v26, s[44:47], s54 offen
  s_mov_b64 exec, -1
  v_min_u32 v26, 23, v1
  v_cmp_lt_u32 vcc, 11, v26
  v_lshlrev_b32 v26, 3, v26
  v_add_u32 v28, 32, v26
  v_cndmask_b32 v26, v26, v28, vcc
  s_mov_b32 s61, 0
POLL_66:
  buffer_load_dwordx2 v[28:29], v26, s[44:47], s54 offen sc0 sc1
  s_waitcnt vmcnt(0)
  v_xor_b32 v28, s32, v29
  v_cmp_ne_u32 vcc, 0, v28
  s_nop 1
  s_cbranch_vccz PD_67
  s_add_u32 s61, s61, 1
  s_cmp_lt_u32 s61, 65536
  s_cbranch_scc1 POLL_66
  s_mov_b32 s52, 11
  s_branch L_timeout
PD_67:
BS_65:
  s_mov_b32 s61, 0
POLL_68:
  buffer_load_dwordx2 v[16:17], v9, s[44:47], s52 offen offset:0 sc0 sc1
  buffer_load_dwordx2 v[18:19], v9, s[44:47], s52 offen offset:512 sc0 sc1
  buffer_load_dwordx2 v[20:21], v9, s[44:47], s52 offen offset:1024 sc0 sc1
  s_waitcnt vmcnt(0)
  v_xor_b32 v36, s32, v17
  v_bitop3_b32 v36, v19, v36, s32 bitop3:0xde
  v_bitop3_b32 v36, v21, v36, s32 bitop3:0xde
  v_cmp_ne_u32 vcc, 0, v36
  s_nop 1
  s_cbranch_vccz PD_69
  s_add_u32 s61, s61, 1
  s_cmp_lt_u32 s61, 65536
  s_cbranch_scc1 POLL_68
  s_mov_b32 s52, 5
  s_branch L_timeout
PD_69:
  ds_write_b32 v10, v16 offset:0
  ds_read_b128 v[48:51], v11 offset:0
  ds_read_b128 v[52:55], v11 offset:64
  ds_read_b128 v[56:59], v11 offset:128
  ds_read_b128 v[60:63], v11 offset:192
  ds_write_b32 v10, v18 offset:256
  ds_read_b128 v[64:67], v11 offset:256
  ds_read_b128 v[68:71], v11 offset:320
  ds_read_b128 v[72:75], v11 offset:384
  ds_read_b128 v[76:79], v11 offset:448
  ds_write_b32 v10, v20 offset:512
  ds_read_b128 v[80:83], v11 offset:512
  ds_read_b128 v[84:87], v11 offset:576
  ds_read_b128 v[88:91], v11 offset:640
  ds_read_b128 v[92:95], v11 offset:704
  s_waitcnt lgkmcnt(13)
  v_mfma_f32_16x16x32_bf16 v[40:43], v[48:51], v[176:179], 0
  s_waitcnt lgkmcnt(12)
  v_mfma_f32_16x16x32_bf16 v[44:47], v[52:55], v[180:183], 0
  s_waitcnt lgkmcnt(11)
  v_mfma_f32_16x16x32_bf16 v[40:43], v[56:59], v[184:187], v[40:43]
  s_waitcnt lgkmcnt(10)
  v_mfma_f32_16x16x32_bf16 v[44:47], v[60:63], v[188:191], v[44:47]
  s_waitcnt lgkmcnt(8)
  v_mfma_f32_16x16x32_bf16 v[40:43], v[64:67], v[192:195], v[40:43]
  s_waitcnt lgkmcnt(7)
  v_mfma_f32_16x16x32_bf16 v[44:47], v[68:71], v[196:199], v[44:47]
  s_waitcnt lgkmcnt(6)
  v_mfma_f32_16x16x32_bf16 v[40:43], v[72:75], v[200:203], v[40:43]
  s_waitcnt lgkmcnt(5)
  v_mfma_f32_16x16x32_bf16 v[44:47], v[76:79], v[204:207], v[44:47]
  s_waitcnt lgkmcnt(3)
  v_mfma_f32_16x16x32_bf16 v[40:43], v[80:83], v[208:211], v[40:43]
  s_waitcnt lgkmcnt(2)
  v_mfma_f32_16x16x32_bf16 v[44:47], v[84:87], v[212:215], v[44:47]
  s_waitcnt lgkmcnt(1)
  v_mfma_f32_16x16x32_bf16 v[40:43], v[88:91], v[216:219], v[40:43]
  s_waitcnt lgkmcnt(0)
  v_mfma_f32_16x16x32_bf16 v[44:47], v[92:95], v[220:223], v[44:47]
  s_nop 7
  v_add_f32 v16, v40, v44
  ds_write_b32 v13, v16 offset:12800
  s_waitcnt lgkmcnt(0)
  s_barrier
  s_cmp_lg_u32 s31, 0
  s_cbranch_scc1 L_fin
  ds_read_b32 v16, v12 offset:12800
  ds_read_b32 v17, v12 offset:12864
  ds_read_b32 v18, v12 offset:12928
  ds_read_b32 v19, v12 offset:12992
  v_lshrrev_b32 v37, 2, v7
  s_waitcnt lgkmcnt(0)
  v_add_f32 v16, v16, v17
  v_add_f32 v18, v18, v19
  v_add_f32 v16, v16, v18
  v_cvt_pk_bf16_f32 v16, v16, v16
  v_and_b32 v16, 0xffff0000, v16
  v_add_f32 v16, v16, v14
  v_cvt_pk_bf16_f32 v16, v16, v16
  s_mov_b64 exec, 0xffff
  buffer_store_short v16, v37, s[36:39], s56 offen
  s_mov_b64 exec, -1
  s_cmp_lg_u32 s2, 0
  s_cbranch_scc1 L_fin
  v_mov_b32 v38, s32
  v_mov_b32 v39, 0
  s_mov_b64 exec, 1
  buffer_store_dword v38, v39, s[48:51], 0 offen sc0 sc1
  s_mov_b64 exec, -1
L_fin:
  s_endpgm
L_timeout:
  s_mov_b32 s36, s24
  s_mov_b32 s37, s25
  s_and_b32 s37, s37, 0xffff
  s_mov_b32 s38, 256
  s_mov_b32 s39, 0x20000
  v_mov_b32 v4, s52
  s_lshl_b32 s53, s52, 2
  v_mov_b32 v5, s53
  s_mov_b64 exec, 1
  buffer_store_dword v4, v5, s[36:39], 0 offen
L_end:
  s_endpgm
L_stream:
  v_mul_u32_u24 v1, 384, v2
  v_lshl_add_u32 v1, v3, 4, v1
  s_lshl_b32 s53, s30, 2
  s_add_u32 s53, s53, s31
  s_mul_i32 s58, s53, 12288
  s_mul_i32 s52, s29, 12582912
  s_waitcnt lgkmcnt(0)
  s_add_u32 s36, s6, s52
  s_addc_u32 s37, s7, 0
  s_and_b32 s37, s37, 0xffff
  s_mov_b32 s38, 12582912
  s_mov_b32 s39, 0x20000
  s_add_u32 s40, s8, s52
  s_addc_u32 s41, s9, 0
  s_and_b32 s41, s41, 0xffff
  s_mov_b32 s42, 12582912
  s_mov_b32 s43, 0x20000
  s_barrier
  s_mov_b32 s65, s58
  s_add_u32 s66, s58, 393216
  s_add_u32 s67, s66, 393216
  s_mov_b32 s60, 0
  v_mov_b32 v62, 0
  s_mov_b64 exec, 1
  buffer_load_dword v63, v62, s[36:39], s65 offen nt
  buffer_load_dword v63, v62, s[40:43], s65 offen nt
  s_mov_b64 exec, -1
  s_mov_b32 s58, s65
  s_add_u32 s59, s58, 0
  buffer_load_dwordx4 v[64:67], v1, s[36:39], s59 offen offset:0 nt
  buffer_load_dwordx4 v[68:71], v1, s[36:39], s59 offen offset:128 nt
  buffer_load_dwordx4 v[72:75], v1, s[36:39], s59 offen offset:256 nt
  s_add_u32 s59, s58, 3072
  buffer_load_dwordx4 v[76:79], v1, s[36:39], s59 offen offset:0 nt
  buffer_load_dwordx4 v[80:83], v1, s[36:39], s59 offen offset:128 nt
  buffer_load_dwordx4 v[84:87], v1, s[36:39], s59 offen offset:256 nt
  s_add_u32 s59, s58, 6144
  buffer_load_dwordx4 v[88:91], v1, s[36:39], s59 offen offset:0 nt
  buffer_load_dwordx4 v[92:95], v1, s[36:39], s59 offen offset:128 nt
  buffer_load_dwordx4 v[96:99], v1, s[36:39], s59 offen offset:256 nt
  s_add_u32 s59, s58, 9216
  buffer_load_dwordx4 v[100:103], v1, s[36:39], s59 offen offset:0 nt
  buffer_load_dwordx4 v[104:107], v1, s[36:39], s59 offen offset:128 nt
  buffer_load_dwordx4 v[108:111], v1, s[36:39], s59 offen offset:256 nt
  v_mov_b32 v16, 0
  v_mov_b32 v17, 0
  v_mov_b32 v18, 0
  v_mov_b32 v19, 0
  v_mov_b32 v20, 0
  v_mov_b32 v21, 0
  v_mov_b32 v22, 0
  v_mov_b32 v23, 0
  v_mov_b32 v24, 0
  v_mov_b32 v25, 0
  v_mov_b32 v26, 0
  v_mov_b32 v27, 0
  v_mov_b32 v28, 0
  v_mov_b32 v29, 0
  v_mov_b32 v30, 0
  v_mov_b32 v31, 0
  v_mov_b32 v32, 0
  v_mov_b32 v33, 0
  v_mov_b32 v34, 0
  v_mov_b32 v35, 0
  v_mov_b32 v36, 0
  v_mov_b32 v37, 0
  v_mov_b32 v38, 0
  v_mov_b32 v39, 0
  v_mov_b32 v2, 0xff800000
  v_mov_b32 v3, 0
  v_mov_b32 v57, 0
  v_and_b32 v61, 7, v0
  v_lshlrev_b32 v61, 4, v61
  s_barrier
  s_add_u32 s59, s58, 0
  buffer_load_dwordx4 v[112:115], v1, s[40:43], s59 offen offset:0 nt
  buffer_load_dwordx4 v[116:119], v1, s[40:43], s59 offen offset:128 nt
  buffer_load_dwordx4 v[120:123], v1, s[40:43], s59 offen offset:256 nt
  s_add_u32 s59, s58, 3072
  buffer_load_dwordx4 v[124:127], v1, s[40:43], s59 offen offset:0 nt
  buffer_load_dwordx4 v[128:131], v1, s[40:43], s59 offen offset:128 nt
  buffer_load_dwordx4 v[132:135], v1, s[40:43], s59 offen offset:256 nt
  s_add_u32 s59, s58, 6144
  buffer_load_dwordx4 v[136:139], v1, s[40:43], s59 offen offset:0 nt
  buffer_load_dwordx4 v[140:143], v1, s[40:43], s59 offen offset:128 nt
  buffer_load_dwordx4 v[144:147], v1, s[40:43], s59 offen offset:256 nt
  s_add_u32 s59, s58, 9216
  buffer_load_dwordx4 v[148:151], v1, s[40:43], s59 offen offset:0 nt
  buffer_load_dwordx4 v[152:155], v1, s[40:43], s59 offen offset:128 nt
  buffer_load_dwordx4 v[156:159], v1, s[40:43], s59 offen offset:256 nt
  s_barrier
  s_mov_b32 s58, s66
  s_add_u32 s59, s58, 0
  buffer_load_dwordx4 v[160:163], v1, s[36:39], s59 offen offset:0 nt
  buffer_load_dwordx4 v[164:167], v1, s[36:39], s59 offen offset:128 nt
  buffer_load_dwordx4 v[168:171], v1, s[36:39], s59 offen offset:256 nt
  s_add_u32 s59, s58, 3072
  buffer_load_dwordx4 v[172:175], v1, s[36:39], s59 offen offset:0 nt
  buffer_load_dwordx4 v[176:179], v1, s[36:39], s59 offen offset:128 nt
  buffer_load_dwordx4 v[180:183], v1, s[36:39], s59 offen offset:256 nt
  s_add_u32 s59, s58, 6144
  buffer_load_dwordx4 v[184:187], v1, s[36:39], s59 offen offset:0 nt
  buffer_load_dwordx4 v[188:191], v1, s[36:39], s59 offen offset:128 nt
  buffer_load_dwordx4 v[192:195], v1, s[36:39], s59 offen offset:256 nt
  s_add_u32 s59, s58, 9216
  buffer_load_dwordx4 v[196:199], v1, s[36:39], s59 offen offset:0 nt
  buffer_load_dwordx4 v[200:203], v1, s[36:39], s59 offen offset:128 nt
  buffer_load_dwordx4 v[204:207], v1, s[36:39], s59 offen offset:256 nt
  s_add_u32 s59, s58, 0
  buffer_load_dwordx4 v[208:211], v1, s[40:43], s59 offen offset:0 nt
  buffer_load_dwordx4 v[212:215], v1, s[40:43], s59 offen offset:128 nt
  buffer_load_dwordx4 v[216:219], v1, s[40:43], s59 offen offset:256 nt
  s_add_u32 s59, s58, 3072
  buffer_load_dwordx4 v[220:223], v1, s[40:43], s59 offen offset:0 nt
  buffer_load_dwordx4 v[224:227], v1, s[40:43], s59 offen offset:128 nt
  buffer_load_dwordx4 v[228:231], v1, s[40:43], s59 offen offset:256 nt
  s_add_u32 s59, s58, 6144
  buffer_load_dwordx4 v[232:235], v1, s[40:43], s59 offen offset:0 nt
  buffer_load_dwordx4 v[236:239], v1, s[40:43], s59 offen offset:128 nt
  buffer_load_dwordx4 v[240:243], v1, s[40:43], s59 offen offset:256 nt
  s_add_u32 s59, s58, 9216
  buffer_load_dwordx4 v[244:247], v1, s[40:43], s59 offen offset:0 nt
  buffer_load_dwordx4 v[248:251], v1, s[40:43], s59 offen offset:128 nt
  buffer_load_dwordx4 v[252:255], v1, s[40:43], s59 offen offset:256 nt
  ds_read_b128 v[4:7], v61 offset:3072
  ds_read_b128 v[8:11], v61 offset:3200
  ds_read_b128 v[12:15], v61 offset:3328
  s_waitcnt lgkmcnt(0)
  s_mul_i32 s52, s29, 245760
  s_mul_i32 s53, s30, 128
  s_add_u32 s52, s52, s53
  s_mul_i32 s53, s31, 61440
  s_add_u32 s52, s52, s53
  s_add_u32 s48, s12, s52
  s_addc_u32 s49, s13, 0
  s_and_b32 s49, s49, 0xffff
  s_sub_u32 s50, 7864320, s52
  s_mov_b32 s51, 0x20000
  s_cmp_ge_u32 s31, 2
  s_cbranch_scc1 WM_71
  s_mul_i32 s52, s29, 61440
  s_lshl_b32 s53, s30, 7
  s_add_u32 s52, s52, s53
  s_cmp_eq_u32 s31, 0
  s_cselect_b32 s54, s16, s18
  s_cselect_b32 s55, s17, s19
  s_add_u32 s44, s54, s52
  s_addc_u32 s45, s55, 0
  s_and_b32 s45, s45, 0xffff
  s_sub_u32 s46, 1966080, s52
  s_mov_b32 s47, 0x20000
  s_branch WM_70
WM_71:
  s_mul_i32 s52, s29, 61440
  s_lshl_b32 s53, s30, 7
  s_add_u32 s52, s52, s53
  s_sub_u32 s53, s31, 2
  s_lshl_b32 s53, s53, 10
  s_add_u32 s52, s52, s53
  s_lshr_b32 s53, s30, 1
  s_sub_u32 s53, s53, s30
  s_lshl_b32 s53, s53, 7
  s_cmp_eq_u32 s31, 3
  s_cselect_b32 s53, s53, 0
  s_add_u32 s52, s52, s53
  s_add_u32 s44, s20, s52
  s_addc_u32 s45, s21, 0
  s_and_b32 s45, s45, 0xffff
  s_sub_u32 s46, 1966080, s52
  s_mov_b32 s47, 0x20000
  s_cmp_eq_u32 s31, 3
  s_cselect_b32 s53, s30, 0
  s_cmp_ge_u32 s53, 4
  s_cselect_b32 s46, 0, s46
WM_70:
  v_and_b32 v40, 63, v0
  v_lshrrev_b32 v41, 3, v40
  v_and_b32 v42, 7, v40
  v_and_b32 v43, 3, v41
  v_lshlrev_b32 v43, 1, v43
  v_xor_b32 v42, v42, v43
  v_mul_u32_u24 v61, 1280, v41
  v_lshl_add_u32 v61, v42, 4, v61
  s_mul_i32 s22, s31, 6144
  s_add_u32 s22, s22, 13824
  s_mov_b32 s4, 9216
  s_mov_b32 s5, 18432
  s_mov_b32 s6, 27648
  s_mov_b32 s7, 40960
  s_mov_b32 s8, 50176
  v_lshrrev_b32 v41, 4, v40
  v_mul_u32_u24 v41, 192, v41
  v_and_b32 v40, 7, v40
  v_lshl_add_u32 v41, v40, 2, v41
  s_mul_i32 s52, s31, 768
  v_add_u32 v62, s52, v41
  s_mov_b32 s64, 0
  s_mov_b32 s68, 13072
  s_lshl_b32 s69, s31, 2
  s_add_u32 s69, s69, 13056
  s_mov_b32 s14, 0
  s_mov_b32 s15, 0
  s_mov_b32 s16, 0
  s_mov_b32 s17, 0
  s_mov_b32 s18, 0
  s_mov_b32 s19, 0
L_sloop:
  s_cmp_ge_u32 s65, 12582912
  s_cbranch_scc1 L_sfin
  s_mov_b32 s20, 4
  v_mov_b32 v59, s60
  v_mov_b32 v60, s69
  ds_write_b32 v60, v59
  s_mov_b32 s58, s67
  s_cmp_lt_u32 s60, 24
  s_cbranch_scc1 GO_72
  s_mov_b32 s58, 12582912
  s_cmp_lg_u32 s64, 0
  s_cbranch_scc1 GO_72
  v_mov_b32 v60, s68
  s_mov_b32 s61, 0
SPIN_73:
  ds_read_b32 v59, v60
  s_add_u32 s61, s61, 1
  s_cmp_ge_u32 s61, 1048576
  s_mov_b32 s52, 7
  s_cbranch_scc1 L_stimeout
  s_waitcnt lgkmcnt(0)
  v_readfirstlane_b32 s52, v59
  s_cmp_eq_u32 s52, -1
  s_cbranch_scc1 SPIN_73
  s_add_u32 s68, s68, 4
  s_and_b32 s20, s52, 7
  s_lshr_b32 s52, s52, 3
  s_mul_i32 s53, s20, s31
  s_add_u32 s52, s52, s53
  s_cmp_ge_u32 s52, 768
  s_cselect_b32 s64, 1, 0
  s_cbranch_scc1 GO_72
  s_add_u32 s52, s52, 3328
  s_mul_i32 s58, s52, 3072
GO_72:
  s_mov_b32 s10, s58
  s_add_u32 s52, s58, 3072
  s_cmp_gt_u32 s20, 1
  s_cselect_b32 s11, s52, 12582912
  s_add_u32 s52, s58, 6144
  s_cmp_gt_u32 s20, 2
  s_cselect_b32 s12, s52, 12582912
  s_add_u32 s52, s58, 9216
  s_cmp_gt_u32 s20, 3
  s_cselect_b32 s13, s52, 12582912
  s_add_u32 s67, s67, 393216
  s_add_u32 s60, s60, 1
  s_mov_b32 s65, s58
  s_waitcnt vmcnt(45)
  v_dot2_f32_bf16 v40, v64, v4, 0
  v_dot2_f32_bf16 v41, v68, v8, 0
  v_dot2_f32_bf16 v42, v72, v12, 0
  v_dot2_f32_bf16 v40, v65, v5, v40
  v_dot2_f32_bf16 v41, v69, v9, v41
  v_dot2_f32_bf16 v42, v73, v13, v42
  v_dot2_f32_bf16 v40, v66, v6, v40
  v_dot2_f32_bf16 v41, v70, v10, v41
  v_dot2_f32_bf16 v42, v74, v14, v42
  v_dot2_f32_bf16 v40, v67, v7, v40
  v_dot2_f32_bf16 v41, v71, v11, v41
  v_dot2_f32_bf16 v42, v75, v15, v42
  buffer_load_dwordx4 v[64:67], v1, s[36:39], s10 offen offset:0 nt
  buffer_load_dwordx4 v[68:71], v1, s[36:39], s10 offen offset:128 nt
  buffer_load_dwordx4 v[72:75], v1, s[36:39], s10 offen offset:256 nt
  v_add_f32 v52, v40, v41
  v_add_f32 v52, v52, v42
  s_waitcnt vmcnt(45)
  v_dot2_f32_bf16 v43, v76, v4, 0
  v_dot2_f32_bf16 v44, v80, v8, 0
  v_dot2_f32_bf16 v45, v84, v12, 0
  v_dot2_f32_bf16 v43, v77, v5, v43
  v_dot2_f32_bf16 v44, v81, v9, v44
  v_dot2_f32_bf16 v45, v85, v13, v45
  v_dot2_f32_bf16 v43, v78, v6, v43
  v_dot2_f32_bf16 v44, v82, v10, v44
  v_dot2_f32_bf16 v45, v86, v14, v45
  v_dot2_f32_bf16 v43, v79, v7, v43
  v_dot2_f32_bf16 v44, v83, v11, v44
  v_dot2_f32_bf16 v45, v87, v15, v45
  buffer_load_dwordx4 v[76:79], v1, s[36:39], s11 offen offset:0 nt
  buffer_load_dwordx4 v[80:83], v1, s[36:39], s11 offen offset:128 nt
  buffer_load_dwordx4 v[84:87], v1, s[36:39], s11 offen offset:256 nt
  v_add_f32 v53, v43, v44
  v_add_f32 v53, v53, v45
  s_waitcnt vmcnt(45)
  v_dot2_f32_bf16 v46, v88, v4, 0
  v_dot2_f32_bf16 v47, v92, v8, 0
  v_dot2_f32_bf16 v48, v96, v12, 0
  v_dot2_f32_bf16 v46, v89, v5, v46
  v_dot2_f32_bf16 v47, v93, v9, v47
  v_dot2_f32_bf16 v48, v97, v13, v48
  v_dot2_f32_bf16 v46, v90, v6, v46
  v_dot2_f32_bf16 v47, v94, v10, v47
  v_dot2_f32_bf16 v48, v98, v14, v48
  v_dot2_f32_bf16 v46, v91, v7, v46
  v_dot2_f32_bf16 v47, v95, v11, v47
  v_dot2_f32_bf16 v48, v99, v15, v48
  buffer_load_dwordx4 v[88:91], v1, s[36:39], s12 offen offset:0 nt
  buffer_load_dwordx4 v[92:95], v1, s[36:39], s12 offen offset:128 nt
  buffer_load_dwordx4 v[96:99], v1, s[36:39], s12 offen offset:256 nt
  v_add_f32 v54, v46, v47
  v_add_f32 v54, v54, v48
  s_waitcnt vmcnt(45)
  v_dot2_f32_bf16 v49, v100, v4, 0
  v_dot2_f32_bf16 v50, v104, v8, 0
  v_dot2_f32_bf16 v51, v108, v12, 0
  v_dot2_f32_bf16 v49, v101, v5, v49
  v_dot2_f32_bf16 v50, v105, v9, v50
  v_dot2_f32_bf16 v51, v109, v13, v51
  v_dot2_f32_bf16 v49, v102, v6, v49
  v_dot2_f32_bf16 v50, v106, v10, v50
  v_dot2_f32_bf16 v51, v110, v14, v51
  v_dot2_f32_bf16 v49, v103, v7, v49
  v_dot2_f32_bf16 v50, v107, v11, v50
  v_dot2_f32_bf16 v51, v111, v15, v51
  buffer_load_dwordx4 v[100:103], v1, s[36:39], s13 offen offset:0 nt
  buffer_load_dwordx4 v[104:107], v1, s[36:39], s13 offen offset:128 nt
  buffer_load_dwordx4 v[108:111], v1, s[36:39], s13 offen offset:256 nt
  v_add_f32 v55, v49, v50
  v_add_f32 v55, v55, v51
  s_nop 0
  v_add_f32_dpp v52, v52, v52 quad_perm:[1,0,3,2] row_mask:0xf bank_mask:0xf
  v_add_f32_dpp v53, v53, v53 quad_perm:[1,0,3,2] row_mask:0xf bank_mask:0xf
  v_add_f32_dpp v54, v54, v54 quad_perm:[1,0,3,2] row_mask:0xf bank_mask:0xf
  v_add_f32_dpp v55, v55, v55 quad_perm:[1,0,3,2] row_mask:0xf bank_mask:0xf
  v_add_f32_dpp v52, v52, v52 quad_perm:[2,3,0,1] row_mask:0xf bank_mask:0xf
  v_add_f32_dpp v53, v53, v53 quad_perm:[2,3,0,1] row_mask:0xf bank_mask:0xf
  v_add_f32_dpp v54, v54, v54 quad_perm:[2,3,0,1] row_mask:0xf bank_mask:0xf
  v_add_f32_dpp v55, v55, v55 quad_perm:[2,3,0,1] row_mask:0xf bank_mask:0xf
  v_add_f32_dpp v52, v52, v52 row_half_mirror row_mask:0xf bank_mask:0xf
  v_add_f32_dpp v53, v53, v53 row_half_mirror row_mask:0xf bank_mask:0xf
  v_add_f32_dpp v54, v54, v54 row_half_mirror row_mask:0xf bank_mask:0xf
  v_add_f32_dpp v55, v55, v55 row_half_mirror row_mask:0xf bank_mask:0xf
  v_cvt_pk_bf16_f32 v48, v52, v53
  v_cvt_pk_bf16_f32 v49, v54, v55
  v_lshlrev_b32 v52, 16, v48
  v_and_b32 v53, s35, v48
  v_lshlrev_b32 v54, 16, v49
  v_and_b32 v55, s35, v49
  v_mul_f32 v52, s34, v52
  v_mul_f32 v53, s34, v53
  v_mul_f32 v54, s34, v54
  v_mul_f32 v55, s34, v55
  v_cvt_pk_bf16_f32 v48, v52, v53
  v_cvt_pk_bf16_f32 v49, v54, v55
  v_lshlrev_b32 v52, 16, v48
  v_and_b32 v53, s35, v48
  v_lshlrev_b32 v54, 16, v49
  v_and_b32 v55, s35, v49
  v_max3_f32 v58, v52, v53, v54
  v_max3_f32 v58, v58, v55, v2
  s_nop 1
  v_max_f32_dpp v58, v58, v58 row_ror:8 row_mask:0xf bank_mask:0xf
  v_mov_b32 v48, v58
  s_nop 1
  v_permlane16_swap_b32 v58, v48
  v_max_f32 v58, v58, v48
  v_mov_b32 v48, v58
  s_nop 1
  v_permlane32_swap_b32 v58, v48
  v_max_f32 v58, v58, v48
  v_sub_f32 v56, v2, v58
  v_sub_f32 v52, v52, v58
  v_sub_f32 v53, v53, v58
  v_sub_f32 v54, v54, v58
  v_sub_f32 v55, v55, v58
  v_mul_f32 v56, s33, v56
  v_mul_f32 v52, s33, v52
  v_mul_f32 v53, s33, v53
  v_mul_f32 v54, s33, v54
  v_mul_f32 v55, s33, v55
  v_exp_f32 v56, v56
  v_exp_f32 v52, v52
  v_exp_f32 v53, v53
  v_exp_f32 v54, v54
  v_exp_f32 v55, v55
  v_mov_b32 v2, v58
  v_add_f32 v48, v52, v53
  v_add_f32 v49, v54, v55
  v_cvt_pk_bf16_f32 v40, v52, 0
  v_cvt_pk_bf16_f32 v44, 0, v52
  v_cvt_pk_bf16_f32 v41, v53, 0
  v_cvt_pk_bf16_f32 v45, 0, v53
  v_cvt_pk_bf16_f32 v42, v54, 0
  v_cvt_pk_bf16_f32 v46, 0, v54
  v_cvt_pk_bf16_f32 v43, v55, 0
  v_cvt_pk_bf16_f32 v47, 0, v55
  v_add_f32 v48, v48, v49
  v_pk_mul_f32 v[16:17], v[16:17], v[56:57] op_sel_hi:[1,0]
  v_pk_mul_f32 v[18:19], v[18:19], v[56:57] op_sel_hi:[1,0]
  v_pk_mul_f32 v[20:21], v[20:21], v[56:57] op_sel_hi:[1,0]
  v_pk_mul_f32 v[22:23], v[22:23], v[56:57] op_sel_hi:[1,0]
  v_pk_mul_f32 v[24:25], v[24:25], v[56:57] op_sel_hi:[1,0]
  v_pk_mul_f32 v[26:27], v[26:27], v[56:57] op_sel_hi:[1,0]
  v_pk_mul_f32 v[28:29], v[28:29], v[56:57] op_sel_hi:[1,0]
  v_pk_mul_f32 v[30:31], v[30:31], v[56:57] op_sel_hi:[1,0]
  v_pk_mul_f32 v[32:33], v[32:33], v[56:57] op_sel_hi:[1,0]
  v_pk_mul_f32 v[34:35], v[34:35], v[56:57] op_sel_hi:[1,0]
  v_pk_mul_f32 v[36:37], v[36:37], v[56:57] op_sel_hi:[1,0]
  v_pk_mul_f32 v[38:39], v[38:39], v[56:57] op_sel_hi:[1,0]
  v_fma_f32 v3, v3, v56, v48
  s_waitcnt vmcnt(45)
  v_dot2_f32_bf16 v16, v112, v40, v16
  v_dot2_f32_bf16 v17, v112, v44, v17
  v_dot2_f32_bf16 v18, v113, v40, v18
  v_dot2_f32_bf16 v19, v113, v44, v19
  v_dot2_f32_bf16 v20, v114, v40, v20
  v_dot2_f32_bf16 v21, v114, v44, v21
  v_dot2_f32_bf16 v22, v115, v40, v22
  v_dot2_f32_bf16 v23, v115, v44, v23
  v_dot2_f32_bf16 v24, v116, v40, v24
  v_dot2_f32_bf16 v25, v116, v44, v25
  v_dot2_f32_bf16 v26, v117, v40, v26
  v_dot2_f32_bf16 v27, v117, v44, v27
  v_dot2_f32_bf16 v28, v118, v40, v28
  v_dot2_f32_bf16 v29, v118, v44, v29
  v_dot2_f32_bf16 v30, v119, v40, v30
  v_dot2_f32_bf16 v31, v119, v44, v31
  v_dot2_f32_bf16 v32, v120, v40, v32
  v_dot2_f32_bf16 v33, v120, v44, v33
  v_dot2_f32_bf16 v34, v121, v40, v34
  v_dot2_f32_bf16 v35, v121, v44, v35
  v_dot2_f32_bf16 v36, v122, v40, v36
  v_dot2_f32_bf16 v37, v122, v44, v37
  v_dot2_f32_bf16 v38, v123, v40, v38
  v_dot2_f32_bf16 v39, v123, v44, v39
  buffer_load_dwordx4 v[112:115], v1, s[40:43], s10 offen offset:0 nt
  buffer_load_dwordx4 v[116:119], v1, s[40:43], s10 offen offset:128 nt
  buffer_load_dwordx4 v[120:123], v1, s[40:43], s10 offen offset:256 nt
  s_waitcnt vmcnt(45)
  v_dot2_f32_bf16 v16, v124, v41, v16
  v_dot2_f32_bf16 v17, v124, v45, v17
  v_dot2_f32_bf16 v18, v125, v41, v18
  v_dot2_f32_bf16 v19, v125, v45, v19
  v_dot2_f32_bf16 v20, v126, v41, v20
  v_dot2_f32_bf16 v21, v126, v45, v21
  v_dot2_f32_bf16 v22, v127, v41, v22
  v_dot2_f32_bf16 v23, v127, v45, v23
  v_dot2_f32_bf16 v24, v128, v41, v24
  v_dot2_f32_bf16 v25, v128, v45, v25
  v_dot2_f32_bf16 v26, v129, v41, v26
  v_dot2_f32_bf16 v27, v129, v45, v27
  v_dot2_f32_bf16 v28, v130, v41, v28
  v_dot2_f32_bf16 v29, v130, v45, v29
  v_dot2_f32_bf16 v30, v131, v41, v30
  v_dot2_f32_bf16 v31, v131, v45, v31
  v_dot2_f32_bf16 v32, v132, v41, v32
  v_dot2_f32_bf16 v33, v132, v45, v33
  v_dot2_f32_bf16 v34, v133, v41, v34
  v_dot2_f32_bf16 v35, v133, v45, v35
  v_dot2_f32_bf16 v36, v134, v41, v36
  v_dot2_f32_bf16 v37, v134, v45, v37
  v_dot2_f32_bf16 v38, v135, v41, v38
  v_dot2_f32_bf16 v39, v135, v45, v39
  buffer_load_dwordx4 v[124:127], v1, s[40:43], s11 offen offset:0 nt
  buffer_load_dwordx4 v[128:131], v1, s[40:43], s11 offen offset:128 nt
  buffer_load_dwordx4 v[132:135], v1, s[40:43], s11 offen offset:256 nt
  s_waitcnt vmcnt(45)
  v_dot2_f32_bf16 v16, v136, v42, v16
  v_dot2_f32_bf16 v17, v136, v46, v17
  v_dot2_f32_bf16 v18, v137, v42, v18
  v_dot2_f32_bf16 v19, v137, v46, v19
  v_dot2_f32_bf16 v20, v138, v42, v20
  v_dot2_f32_bf16 v21, v138, v46, v21
  v_dot2_f32_bf16 v22, v139, v42, v22
  v_dot2_f32_bf16 v23, v139, v46, v23
  v_dot2_f32_bf16 v24, v140, v42, v24
  v_dot2_f32_bf16 v25, v140, v46, v25
  v_dot2_f32_bf16 v26, v141, v42, v26
  v_dot2_f32_bf16 v27, v141, v46, v27
  v_dot2_f32_bf16 v28, v142, v42, v28
  v_dot2_f32_bf16 v29, v142, v46, v29
  v_dot2_f32_bf16 v30, v143, v42, v30
  v_dot2_f32_bf16 v31, v143, v46, v31
  v_dot2_f32_bf16 v32, v144, v42, v32
  v_dot2_f32_bf16 v33, v144, v46, v33
  v_dot2_f32_bf16 v34, v145, v42, v34
  v_dot2_f32_bf16 v35, v145, v46, v35
  v_dot2_f32_bf16 v36, v146, v42, v36
  v_dot2_f32_bf16 v37, v146, v46, v37
  v_dot2_f32_bf16 v38, v147, v42, v38
  v_dot2_f32_bf16 v39, v147, v46, v39
  buffer_load_dwordx4 v[136:139], v1, s[40:43], s12 offen offset:0 nt
  buffer_load_dwordx4 v[140:143], v1, s[40:43], s12 offen offset:128 nt
  buffer_load_dwordx4 v[144:147], v1, s[40:43], s12 offen offset:256 nt
  s_waitcnt vmcnt(45)
  v_dot2_f32_bf16 v16, v148, v43, v16
  v_dot2_f32_bf16 v17, v148, v47, v17
  v_dot2_f32_bf16 v18, v149, v43, v18
  v_dot2_f32_bf16 v19, v149, v47, v19
  v_dot2_f32_bf16 v20, v150, v43, v20
  v_dot2_f32_bf16 v21, v150, v47, v21
  v_dot2_f32_bf16 v22, v151, v43, v22
  v_dot2_f32_bf16 v23, v151, v47, v23
  v_dot2_f32_bf16 v24, v152, v43, v24
  v_dot2_f32_bf16 v25, v152, v47, v25
  v_dot2_f32_bf16 v26, v153, v43, v26
  v_dot2_f32_bf16 v27, v153, v47, v27
  v_dot2_f32_bf16 v28, v154, v43, v28
  v_dot2_f32_bf16 v29, v154, v47, v29
  v_dot2_f32_bf16 v30, v155, v43, v30
  v_dot2_f32_bf16 v31, v155, v47, v31
  v_dot2_f32_bf16 v32, v156, v43, v32
  v_dot2_f32_bf16 v33, v156, v47, v33
  v_dot2_f32_bf16 v34, v157, v43, v34
  v_dot2_f32_bf16 v35, v157, v47, v35
  v_dot2_f32_bf16 v36, v158, v43, v36
  v_dot2_f32_bf16 v37, v158, v47, v37
  v_dot2_f32_bf16 v38, v159, v43, v38
  v_dot2_f32_bf16 v39, v159, v47, v39
  buffer_load_dwordx4 v[148:151], v1, s[40:43], s13 offen offset:0 nt
  buffer_load_dwordx4 v[152:155], v1, s[40:43], s13 offen offset:128 nt
  buffer_load_dwordx4 v[156:159], v1, s[40:43], s13 offen offset:256 nt
  s_cmp_lg_u32 s60, 2
  s_cbranch_scc1 LW8_74
  s_cmp_lt_u32 s30, 6
  s_cbranch_scc1 SK_75
  v_xor_b32 v40, 32, v61
  s_add_u32 m0, s22, 24576
  s_mov_b32 s53, 256
  buffer_load_dwordx4 v61, s[48:51], s53 offen offset:0 lds
  s_mov_b32 s53, 9472
  buffer_load_dwordx4 v40, s[48:51], s53 offen offset:1024 lds
  s_mov_b32 s53, 18688
  buffer_load_dwordx4 v61, s[48:51], s53 offen offset:2048 lds
  s_mov_b32 s53, 27904
  buffer_load_dwordx4 v40, s[48:51], s53 offen offset:3072 lds
  s_add_u32 m0, s22, 28672
  s_mov_b32 s53, 41216
  buffer_load_dwordx4 v61, s[48:51], s53 offen offset:0 lds
  s_mov_b32 s53, 50432
  buffer_load_dwordx4 v40, s[48:51], s53 offen offset:1024 lds
SK_75:
LW8_74:
  s_cmp_ge_u32 s66, 12582912
  s_cbranch_scc1 L_sfin
  s_mov_b32 s20, 4
  v_mov_b32 v59, s60
  v_mov_b32 v60, s69
  ds_write_b32 v60, v59
  s_mov_b32 s58, s67
  s_cmp_lt_u32 s60, 24
  s_cbranch_scc1 GO_76
  s_mov_b32 s58, 12582912
  s_cmp_lg_u32 s64, 0
  s_cbranch_scc1 GO_76
  v_mov_b32 v60, s68
  s_mov_b32 s61, 0
SPIN_77:
  ds_read_b32 v59, v60
  s_add_u32 s61, s61, 1
  s_cmp_ge_u32 s61, 1048576
  s_mov_b32 s52, 7
  s_cbranch_scc1 L_stimeout
  s_waitcnt lgkmcnt(0)
  v_readfirstlane_b32 s52, v59
  s_cmp_eq_u32 s52, -1
  s_cbranch_scc1 SPIN_77
  s_add_u32 s68, s68, 4
  s_and_b32 s20, s52, 7
  s_lshr_b32 s52, s52, 3
  s_mul_i32 s53, s20, s31
  s_add_u32 s52, s52, s53
  s_cmp_ge_u32 s52, 768
  s_cselect_b32 s64, 1, 0
  s_cbranch_scc1 GO_76
  s_add_u32 s52, s52, 3328
  s_mul_i32 s58, s52, 3072
GO_76:
  s_mov_b32 s10, s58
  s_add_u32 s52, s58, 3072
  s_cmp_gt_u32 s20, 1
  s_cselect_b32 s11, s52, 12582912
  s_add_u32 s52, s58, 6144
  s_cmp_gt_u32 s20, 2
  s_cselect_b32 s12, s52, 12582912
  s_add_u32 s52, s58, 9216
  s_cmp_gt_u32 s20, 3
  s_cselect_b32 s13, s52, 12582912
  s_add_u32 s67, s67, 393216
  s_add_u32 s60, s60, 1
  s_mov_b32 s66, s58
  s_waitcnt vmcnt(45)
  v_dot2_f32_bf16 v40, v160, v4, 0
  v_dot2_f32_bf16 v41, v164, v8, 0
  v_dot2_f32_bf16 v42, v168, v12, 0
  v_dot2_f32_bf16 v40, v161, v5, v40
  v_dot2_f32_bf16 v41, v165, v9, v41
  v_dot2_f32_bf16 v42, v169, v13, v42
  v_dot2_f32_bf16 v40, v162, v6, v40
  v_dot2_f32_bf16 v41, v166, v10, v41
  v_dot2_f32_bf16 v42, v170, v14, v42
  v_dot2_f32_bf16 v40, v163, v7, v40
  v_dot2_f32_bf16 v41, v167, v11, v41
  v_dot2_f32_bf16 v42, v171, v15, v42
  buffer_load_dwordx4 v[160:163], v1, s[36:39], s10 offen offset:0 nt
  buffer_load_dwordx4 v[164:167], v1, s[36:39], s10 offen offset:128 nt
  buffer_load_dwordx4 v[168:171], v1, s[36:39], s10 offen offset:256 nt
  v_add_f32 v52, v40, v41
  v_add_f32 v52, v52, v42
  s_waitcnt vmcnt(45)
  v_dot2_f32_bf16 v43, v172, v4, 0
  v_dot2_f32_bf16 v44, v176, v8, 0
  v_dot2_f32_bf16 v45, v180, v12, 0
  v_dot2_f32_bf16 v43, v173, v5, v43
  v_dot2_f32_bf16 v44, v177, v9, v44
  v_dot2_f32_bf16 v45, v181, v13, v45
  v_dot2_f32_bf16 v43, v174, v6, v43
  v_dot2_f32_bf16 v44, v178, v10, v44
  v_dot2_f32_bf16 v45, v182, v14, v45
  v_dot2_f32_bf16 v43, v175, v7, v43
  v_dot2_f32_bf16 v44, v179, v11, v44
  v_dot2_f32_bf16 v45, v183, v15, v45
  buffer_load_dwordx4 v[172:175], v1, s[36:39], s11 offen offset:0 nt
  buffer_load_dwordx4 v[176:179], v1, s[36:39], s11 offen offset:128 nt
  buffer_load_dwordx4 v[180:183], v1, s[36:39], s11 offen offset:256 nt
  v_add_f32 v53, v43, v44
  v_add_f32 v53, v53, v45
  s_waitcnt vmcnt(45)
  v_dot2_f32_bf16 v46, v184, v4, 0
  v_dot2_f32_bf16 v47, v188, v8, 0
  v_dot2_f32_bf16 v48, v192, v12, 0
  v_dot2_f32_bf16 v46, v185, v5, v46
  v_dot2_f32_bf16 v47, v189, v9, v47
  v_dot2_f32_bf16 v48, v193, v13, v48
  v_dot2_f32_bf16 v46, v186, v6, v46
  v_dot2_f32_bf16 v47, v190, v10, v47
  v_dot2_f32_bf16 v48, v194, v14, v48
  v_dot2_f32_bf16 v46, v187, v7, v46
  v_dot2_f32_bf16 v47, v191, v11, v47
  v_dot2_f32_bf16 v48, v195, v15, v48
  buffer_load_dwordx4 v[184:187], v1, s[36:39], s12 offen offset:0 nt
  buffer_load_dwordx4 v[188:191], v1, s[36:39], s12 offen offset:128 nt
  buffer_load_dwordx4 v[192:195], v1, s[36:39], s12 offen offset:256 nt
  v_add_f32 v54, v46, v47
  v_add_f32 v54, v54, v48
  s_waitcnt vmcnt(45)
  v_dot2_f32_bf16 v49, v196, v4, 0
  v_dot2_f32_bf16 v50, v200, v8, 0
  v_dot2_f32_bf16 v51, v204, v12, 0
  v_dot2_f32_bf16 v49, v197, v5, v49
  v_dot2_f32_bf16 v50, v201, v9, v50
  v_dot2_f32_bf16 v51, v205, v13, v51
  v_dot2_f32_bf16 v49, v198, v6, v49
  v_dot2_f32_bf16 v50, v202, v10, v50
  v_dot2_f32_bf16 v51, v206, v14, v51
  v_dot2_f32_bf16 v49, v199, v7, v49
  v_dot2_f32_bf16 v50, v203, v11, v50
  v_dot2_f32_bf16 v51, v207, v15, v51
  buffer_load_dwordx4 v[196:199], v1, s[36:39], s13 offen offset:0 nt
  buffer_load_dwordx4 v[200:203], v1, s[36:39], s13 offen offset:128 nt
  buffer_load_dwordx4 v[204:207], v1, s[36:39], s13 offen offset:256 nt
  v_add_f32 v55, v49, v50
  v_add_f32 v55, v55, v51
  s_nop 0
  v_add_f32_dpp v52, v52, v52 quad_perm:[1,0,3,2] row_mask:0xf bank_mask:0xf
  v_add_f32_dpp v53, v53, v53 quad_perm:[1,0,3,2] row_mask:0xf bank_mask:0xf
  v_add_f32_dpp v54, v54, v54 quad_perm:[1,0,3,2] row_mask:0xf bank_mask:0xf
  v_add_f32_dpp v55, v55, v55 quad_perm:[1,0,3,2] row_mask:0xf bank_mask:0xf
  v_add_f32_dpp v52, v52, v52 quad_perm:[2,3,0,1] row_mask:0xf bank_mask:0xf
  v_add_f32_dpp v53, v53, v53 quad_perm:[2,3,0,1] row_mask:0xf bank_mask:0xf
  v_add_f32_dpp v54, v54, v54 quad_perm:[2,3,0,1] row_mask:0xf bank_mask:0xf
  v_add_f32_dpp v55, v55, v55 quad_perm:[2,3,0,1] row_mask:0xf bank_mask:0xf
  v_add_f32_dpp v52, v52, v52 row_half_mirror row_mask:0xf bank_mask:0xf
  v_add_f32_dpp v53, v53, v53 row_half_mirror row_mask:0xf bank_mask:0xf
  v_add_f32_dpp v54, v54, v54 row_half_mirror row_mask:0xf bank_mask:0xf
  v_add_f32_dpp v55, v55, v55 row_half_mirror row_mask:0xf bank_mask:0xf
  v_cvt_pk_bf16_f32 v48, v52, v53
  v_cvt_pk_bf16_f32 v49, v54, v55
  v_lshlrev_b32 v52, 16, v48
  v_and_b32 v53, s35, v48
  v_lshlrev_b32 v54, 16, v49
  v_and_b32 v55, s35, v49
  v_mul_f32 v52, s34, v52
  v_mul_f32 v53, s34, v53
  v_mul_f32 v54, s34, v54
  v_mul_f32 v55, s34, v55
  v_cvt_pk_bf16_f32 v48, v52, v53
  v_cvt_pk_bf16_f32 v49, v54, v55
  v_lshlrev_b32 v52, 16, v48
  v_and_b32 v53, s35, v48
  v_lshlrev_b32 v54, 16, v49
  v_and_b32 v55, s35, v49
  v_max3_f32 v58, v52, v53, v54
  v_max3_f32 v58, v58, v55, v2
  s_nop 1
  v_max_f32_dpp v58, v58, v58 row_ror:8 row_mask:0xf bank_mask:0xf
  v_mov_b32 v48, v58
  s_nop 1
  v_permlane16_swap_b32 v58, v48
  v_max_f32 v58, v58, v48
  v_mov_b32 v48, v58
  s_nop 1
  v_permlane32_swap_b32 v58, v48
  v_max_f32 v58, v58, v48
  v_sub_f32 v56, v2, v58
  v_sub_f32 v52, v52, v58
  v_sub_f32 v53, v53, v58
  v_sub_f32 v54, v54, v58
  v_sub_f32 v55, v55, v58
  v_mul_f32 v56, s33, v56
  v_mul_f32 v52, s33, v52
  v_mul_f32 v53, s33, v53
  v_mul_f32 v54, s33, v54
  v_mul_f32 v55, s33, v55
  v_exp_f32 v56, v56
  v_exp_f32 v52, v52
  v_exp_f32 v53, v53
  v_exp_f32 v54, v54
  v_exp_f32 v55, v55
  v_mov_b32 v2, v58
  v_add_f32 v48, v52, v53
  v_add_f32 v49, v54, v55
  v_cvt_pk_bf16_f32 v40, v52, 0
  v_cvt_pk_bf16_f32 v44, 0, v52
  v_cvt_pk_bf16_f32 v41, v53, 0
  v_cvt_pk_bf16_f32 v45, 0, v53
  v_cvt_pk_bf16_f32 v42, v54, 0
  v_cvt_pk_bf16_f32 v46, 0, v54
  v_cvt_pk_bf16_f32 v43, v55, 0
  v_cvt_pk_bf16_f32 v47, 0, v55
  v_add_f32 v48, v48, v49
  v_pk_mul_f32 v[16:17], v[16:17], v[56:57] op_sel_hi:[1,0]
  v_pk_mul_f32 v[18:19], v[18:19], v[56:57] op_sel_hi:[1,0]
  v_pk_mul_f32 v[20:21], v[20:21], v[56:57] op_sel_hi:[1,0]
  v_pk_mul_f32 v[22:23], v[22:23], v[56:57] op_sel_hi:[1,0]
  v_pk_mul_f32 v[24:25], v[24:25], v[56:57] op_sel_hi:[1,0]
  v_pk_mul_f32 v[26:27], v[26:27], v[56:57] op_sel_hi:[1,0]
  v_pk_mul_f32 v[28:29], v[28:29], v[56:57] op_sel_hi:[1,0]
  v_pk_mul_f32 v[30:31], v[30:31], v[56:57] op_sel_hi:[1,0]
  v_pk_mul_f32 v[32:33], v[32:33], v[56:57] op_sel_hi:[1,0]
  v_pk_mul_f32 v[34:35], v[34:35], v[56:57] op_sel_hi:[1,0]
  v_pk_mul_f32 v[36:37], v[36:37], v[56:57] op_sel_hi:[1,0]
  v_pk_mul_f32 v[38:39], v[38:39], v[56:57] op_sel_hi:[1,0]
  v_fma_f32 v3, v3, v56, v48
  s_waitcnt vmcnt(45)
  v_dot2_f32_bf16 v16, v208, v40, v16
  v_dot2_f32_bf16 v17, v208, v44, v17
  v_dot2_f32_bf16 v18, v209, v40, v18
  v_dot2_f32_bf16 v19, v209, v44, v19
  v_dot2_f32_bf16 v20, v210, v40, v20
  v_dot2_f32_bf16 v21, v210, v44, v21
  v_dot2_f32_bf16 v22, v211, v40, v22
  v_dot2_f32_bf16 v23, v211, v44, v23
  v_dot2_f32_bf16 v24, v212, v40, v24
  v_dot2_f32_bf16 v25, v212, v44, v25
  v_dot2_f32_bf16 v26, v213, v40, v26
  v_dot2_f32_bf16 v27, v213, v44, v27
  v_dot2_f32_bf16 v28, v214, v40, v28
  v_dot2_f32_bf16 v29, v214, v44, v29
  v_dot2_f32_bf16 v30, v215, v40, v30
  v_dot2_f32_bf16 v31, v215, v44, v31
  v_dot2_f32_bf16 v32, v216, v40, v32
  v_dot2_f32_bf16 v33, v216, v44, v33
  v_dot2_f32_bf16 v34, v217, v40, v34
  v_dot2_f32_bf16 v35, v217, v44, v35
  v_dot2_f32_bf16 v36, v218, v40, v36
  v_dot2_f32_bf16 v37, v218, v44, v37
  v_dot2_f32_bf16 v38, v219, v40, v38
  v_dot2_f32_bf16 v39, v219, v44, v39
  buffer_load_dwordx4 v[208:211], v1, s[40:43], s10 offen offset:0 nt
  buffer_load_dwordx4 v[212:215], v1, s[40:43], s10 offen offset:128 nt
  buffer_load_dwordx4 v[216:219], v1, s[40:43], s10 offen offset:256 nt
  s_waitcnt vmcnt(45)
  v_dot2_f32_bf16 v16, v220, v41, v16
  v_dot2_f32_bf16 v17, v220, v45, v17
  v_dot2_f32_bf16 v18, v221, v41, v18
  v_dot2_f32_bf16 v19, v221, v45, v19
  v_dot2_f32_bf16 v20, v222, v41, v20
  v_dot2_f32_bf16 v21, v222, v45, v21
  v_dot2_f32_bf16 v22, v223, v41, v22
  v_dot2_f32_bf16 v23, v223, v45, v23
  v_dot2_f32_bf16 v24, v224, v41, v24
  v_dot2_f32_bf16 v25, v224, v45, v25
  v_dot2_f32_bf16 v26, v225, v41, v26
  v_dot2_f32_bf16 v27, v225, v45, v27
  v_dot2_f32_bf16 v28, v226, v41, v28
  v_dot2_f32_bf16 v29, v226, v45, v29
  v_dot2_f32_bf16 v30, v227, v41, v30
  v_dot2_f32_bf16 v31, v227, v45, v31
  v_dot2_f32_bf16 v32, v228, v41, v32
  v_dot2_f32_bf16 v33, v228, v45, v33
  v_dot2_f32_bf16 v34, v229, v41, v34
  v_dot2_f32_bf16 v35, v229, v45, v35
  v_dot2_f32_bf16 v36, v230, v41, v36
  v_dot2_f32_bf16 v37, v230, v45, v37
  v_dot2_f32_bf16 v38, v231, v41, v38
  v_dot2_f32_bf16 v39, v231, v45, v39
  buffer_load_dwordx4 v[220:223], v1, s[40:43], s11 offen offset:0 nt
  buffer_load_dwordx4 v[224:227], v1, s[40:43], s11 offen offset:128 nt
  buffer_load_dwordx4 v[228:231], v1, s[40:43], s11 offen offset:256 nt
  s_waitcnt vmcnt(45)
  v_dot2_f32_bf16 v16, v232, v42, v16
  v_dot2_f32_bf16 v17, v232, v46, v17
  v_dot2_f32_bf16 v18, v233, v42, v18
  v_dot2_f32_bf16 v19, v233, v46, v19
  v_dot2_f32_bf16 v20, v234, v42, v20
  v_dot2_f32_bf16 v21, v234, v46, v21
  v_dot2_f32_bf16 v22, v235, v42, v22
  v_dot2_f32_bf16 v23, v235, v46, v23
  v_dot2_f32_bf16 v24, v236, v42, v24
  v_dot2_f32_bf16 v25, v236, v46, v25
  v_dot2_f32_bf16 v26, v237, v42, v26
  v_dot2_f32_bf16 v27, v237, v46, v27
  v_dot2_f32_bf16 v28, v238, v42, v28
  v_dot2_f32_bf16 v29, v238, v46, v29
  v_dot2_f32_bf16 v30, v239, v42, v30
  v_dot2_f32_bf16 v31, v239, v46, v31
  v_dot2_f32_bf16 v32, v240, v42, v32
  v_dot2_f32_bf16 v33, v240, v46, v33
  v_dot2_f32_bf16 v34, v241, v42, v34
  v_dot2_f32_bf16 v35, v241, v46, v35
  v_dot2_f32_bf16 v36, v242, v42, v36
  v_dot2_f32_bf16 v37, v242, v46, v37
  v_dot2_f32_bf16 v38, v243, v42, v38
  v_dot2_f32_bf16 v39, v243, v46, v39
  buffer_load_dwordx4 v[232:235], v1, s[40:43], s12 offen offset:0 nt
  buffer_load_dwordx4 v[236:239], v1, s[40:43], s12 offen offset:128 nt
  buffer_load_dwordx4 v[240:243], v1, s[40:43], s12 offen offset:256 nt
  s_waitcnt vmcnt(45)
  v_dot2_f32_bf16 v16, v244, v43, v16
  v_dot2_f32_bf16 v17, v244, v47, v17
  v_dot2_f32_bf16 v18, v245, v43, v18
  v_dot2_f32_bf16 v19, v245, v47, v19
  v_dot2_f32_bf16 v20, v246, v43, v20
  v_dot2_f32_bf16 v21, v246, v47, v21
  v_dot2_f32_bf16 v22, v247, v43, v22
  v_dot2_f32_bf16 v23, v247, v47, v23
  v_dot2_f32_bf16 v24, v248, v43, v24
  v_dot2_f32_bf16 v25, v248, v47, v25
  v_dot2_f32_bf16 v26, v249, v43, v26
  v_dot2_f32_bf16 v27, v249, v47, v27
  v_dot2_f32_bf16 v28, v250, v43, v28
  v_dot2_f32_bf16 v29, v250, v47, v29
  v_dot2_f32_bf16 v30, v251, v43, v30
  v_dot2_f32_bf16 v31, v251, v47, v31
  v_dot2_f32_bf16 v32, v252, v43, v32
  v_dot2_f32_bf16 v33, v252, v47, v33
  v_dot2_f32_bf16 v34, v253, v43, v34
  v_dot2_f32_bf16 v35, v253, v47, v35
  v_dot2_f32_bf16 v36, v254, v43, v36
  v_dot2_f32_bf16 v37, v254, v47, v37
  v_dot2_f32_bf16 v38, v255, v43, v38
  v_dot2_f32_bf16 v39, v255, v47, v39
  buffer_load_dwordx4 v[244:247], v1, s[40:43], s13 offen offset:0 nt
  buffer_load_dwordx4 v[248:251], v1, s[40:43], s13 offen offset:128 nt
  buffer_load_dwordx4 v[252:255], v1, s[40:43], s13 offen offset:256 nt
  s_cmp_lg_u32 s60, 2
  s_cbranch_scc1 LW8_78
  s_cmp_lt_u32 s30, 6
  s_cbranch_scc1 SK_79
  v_xor_b32 v40, 32, v61
  s_add_u32 m0, s22, 24576
  s_mov_b32 s53, 256
  buffer_load_dwordx4 v61, s[48:51], s53 offen offset:0 lds
  s_mov_b32 s53, 9472
  buffer_load_dwordx4 v40, s[48:51], s53 offen offset:1024 lds
  s_mov_b32 s53, 18688
  buffer_load_dwordx4 v61, s[48:51], s53 offen offset:2048 lds
  s_mov_b32 s53, 27904
  buffer_load_dwordx4 v40, s[48:51], s53 offen offset:3072 lds
  s_add_u32 m0, s22, 28672
  s_mov_b32 s53, 41216
  buffer_load_dwordx4 v61, s[48:51], s53 offen offset:0 lds
  s_mov_b32 s53, 50432
  buffer_load_dwordx4 v40, s[48:51], s53 offen offset:1024 lds
SK_79:
LW8_78:
  s_branch L_sloop
L_sfin:
  v_xor_b32 v40, 32, v61
  s_add_u32 m0, s22, 0
  s_nop 0
  buffer_load_dwordx4 v61, s[48:51], 0 offen offset:0 lds
  s_nop 1
  v_add_f32_dpp v3, v3, v3 row_ror:8 row_mask:0xf bank_mask:0xf
  v_mov_b32 v48, v3
  s_nop 1
  v_permlane16_swap_b32 v3, v48
  v_add_f32 v3, v3, v48
  v_mov_b32 v48, v3
  s_nop 1
  v_permlane32_swap_b32 v3, v48
  v_add_f32 v3, v3, v48
  buffer_load_dwordx4 v40, s[48:51], s4 offen offset:1024 lds
  s_nop 2
  v_permlane32_swap_b32 v16, v28
  v_permlane32_swap_b32 v17, v29
  v_permlane32_swap_b32 v18, v30
  v_permlane32_swap_b32 v19, v31
  v_permlane32_swap_b32 v20, v32
  v_permlane32_swap_b32 v21, v33
  v_permlane32_swap_b32 v22, v34
  v_permlane32_swap_b32 v23, v35
  v_permlane32_swap_b32 v24, v36
  buffer_load_dwordx4 v61, s[48:51], s5 offen offset:2048 lds
  v_permlane32_swap_b32 v25, v37
  v_permlane32_swap_b32 v26, v38
  v_permlane32_swap_b32 v27, v39
  v_add_f32 v16, v16, v28
  v_add_f32 v17, v17, v29
  v_add_f32 v18, v18, v30
  v_add_f32 v19, v19, v31
  v_add_f32 v20, v20, v32
  v_add_f32 v21, v21, v33
  v_add_f32 v22, v22, v34
  buffer_load_dwordx4 v40, s[48:51], s6 offen offset:3072 lds
  v_add_f32 v23, v23, v35
  v_add_f32 v24, v24, v36
  v_add_f32 v25, v25, v37
  v_add_f32 v26, v26, v38
  v_add_f32 v27, v27, v39
  s_nop 1
  v_permlane16_swap_b32 v16, v22
  v_permlane16_swap_b32 v17, v23
  v_permlane16_swap_b32 v18, v24
  v_permlane16_swap_b32 v19, v25
  s_add_u32 m0, s22, 4096
  s_nop 0
  buffer_load_dwordx4 v61, s[48:51], s7 offen offset:0 lds
  v_permlane16_swap_b32 v20, v26
  v_permlane16_swap_b32 v21, v27
  v_add_f32 v16, v16, v22
  v_add_f32 v17, v17, v23
  v_add_f32 v18, v18, v24
  v_add_f32 v19, v19, v25
  v_add_f32 v20, v20, v26
  v_add_f32 v21, v21, v27
  s_nop 0
  v_add_f32_dpp v16, v16, v16 row_ror:8 row_mask:0xf bank_mask:0xf
  buffer_load_dwordx4 v40, s[48:51], s8 offen offset:1024 lds
  v_add_f32_dpp v17, v17, v17 row_ror:8 row_mask:0xf bank_mask:0xf
  v_add_f32_dpp v18, v18, v18 row_ror:8 row_mask:0xf bank_mask:0xf
  v_add_f32_dpp v19, v19, v19 row_ror:8 row_mask:0xf bank_mask:0xf
  v_add_f32_dpp v20, v20, v20 row_ror:8 row_mask:0xf bank_mask:0xf
  v_add_f32_dpp v21, v21, v21 row_ror:8 row_mask:0xf bank_mask:0xf
  ds_write_b32 v62, v16 offset:4096
  ds_write_b32 v62, v17 offset:4128
  ds_write_b32 v62, v18 offset:4160
  ds_write_b32 v62, v19 offset:4192
  ds_write_b32 v62, v20 offset:4224
  ds_write_b32 v62, v21 offset:4256
  s_lshl_b32 s52, s31, 3
  v_mov_b32 v60, s52
  ds_write_b64 v60, v[2:3] offset:7168
  s_waitcnt lgkmcnt(0)
  s_barrier
  s_barrier
  v_and_b32 v61, 63, v0
  s_cmp_ge_u32 s31, 2
  s_cbranch_scc1 WM_81
  v_mul_u32_u24 v59, 21846, v61
  v_lshrrev_b32 v59, 16, v59
  v_mul_u32_u24 v63, 3, v59
  v_sub_u32 v63, v61, v63
  v_mul_u32_u24 v59, 3072, v59
  v_lshl_add_u32 v59, v63, 10, v59
  s_mov_b32 exec_hi, 0x0fffffff
  s_branch WM_80
WM_81:
  v_mul_u32_u24 v59, 1280, v61
  s_mov_b32 exec_hi, 0xffff
WM_80:
  buffer_load_dword v60, v59, s[44:47], 0 offen
  s_mov_b64 exec, -1
  s_lshl_b32 s52, s31, 2
  s_add_u32 s52, s52, 13552
  v_mov_b32 v52, s52
  v_mov_b32 v53, 0
  s_waitcnt vmcnt(1)
  ds_write_b32 v52, v53
  s_waitcnt lgkmcnt(0)
  s_waitcnt vmcnt(0)
  s_waitcnt vmcnt(0)
  s_endpgm
L_stimeout:
  s_mov_b32 s36, s24
  s_mov_b32 s37, s25
  s_and_b32 s37, s37, 0xffff
  s_mov_b32 s38, 256
  s_mov_b32 s39, 0x20000
  v_mov_b32 v4, s52
  s_lshl_b32 s53, s52, 2
  v_mov_b32 v5, s53
  s_mov_b64 exec, 1
  buffer_store_dword v4, v5, s[36:39], 0 offen
  s_endpgm
.section .rodata,"a"
.p2align 6
.amdhsa_kernel sequential_preLN__mha_block_cached__glu_gated_glu__decode_kernel
  .amdhsa_next_free_vgpr 256
  .amdhsa_next_free_sgpr 100
  .amdhsa_accum_offset 256
  .amdhsa_group_segment_fixed_size 0
  .amdhsa_kernarg_size 96
  .amdhsa_user_sgpr_count 2
  .amdhsa_user_sgpr_kernarg_segment_ptr 1
  .amdhsa_system_sgpr_workgroup_id_x 1
  .amdhsa_float_denorm_mode_32 3
.end_amdhsa_kernel
```
